```python
import torch

def _softmax(x, axis=-1):
    return torch.softmax(x, dim=axis)
def _gelu(x):
    return torch.nn.functional.gelu(x, approximate="tanh")
def _silu(x):
    return torch.nn.functional.silu(x)
def _sigmoid(x):
    return torch.sigmoid(x)
def _layernorm(x, axis=-1, eps=1e-5):
    m = x.mean(dim=axis, keepdim=True)
    v = x.var(dim=axis, keepdim=True, unbiased=False)
    return (x - m) / torch.sqrt(v + eps)
def _scatter_add(tgt, idx, src, axis=0):
    return tgt.clone().index_add_(axis, idx, src)
def _segment_sum(src, seg, n):
    out = torch.zeros((n,) + src.shape[1:], dtype=src.dtype)
    return out.index_add_(0, seg, src)
def _pad(x, pw):
    flat = tuple(v for pair in reversed(pw) for v in pair)
    return torch.nn.functional.pad(x, flat)

kernel_name = 'standalone__edge_featured_mpnn_egc__graph'

def setup_inputs():

    _w = (lambda a: (lambda t: t.to(torch.bfloat16) if t.is_floating_point() else t)(torch.as_tensor(a)))
    N, deg, D, De = 12500, 32, 128, max(16, 1)
    E = N * deg
    return {
        "x": _w((lambda *s: torch.randn(*s, dtype=torch.bfloat16) * 0.1)(N, D)),
        "e_attr": _w((lambda *s: torch.randn(*s, dtype=torch.bfloat16) * 0.1)(E, De)),
        "src": _w((lambda lo, hi, *s: torch.randint(lo, hi, s))(0, N, E).to(torch.int64)),
        "dst": _w((lambda lo, hi, *s: torch.randint(lo, hi, s))(0, N, E).to(torch.int64)),
        "u_w": _w((lambda *s: torch.randn(*s, dtype=torch.bfloat16) * 0.05)(D, D)),
        "v_w": _w((lambda *s: torch.randn(*s, dtype=torch.bfloat16) * 0.05)(D, D)),
        "g_w": _w((lambda *s: torch.randn(*s, dtype=torch.bfloat16) * 0.1)(2 * D + De, D)),
    }

def reference(x, e_attr, src, dst, u_w, v_w, g_w):
    N, D = x.shape
    g_in = torch.concatenate([x[dst], x[src], e_attr], axis=-1)
    eta = _sigmoid(g_in @ g_w)
    hv = x @ v_w
    msg = eta * hv[src]
    agg = _segment_sum(msg, dst, N)
    return _silu(x @ u_w + agg)
```

```asm
; @launch kernel=mpnn_prep_kernel grid=(295,1,1) block=(256,1,1) lds=73728
; @launch kernel=mpnn_main_kernel grid=(1024,1,1) block=(256,1,1) lds=37808
.amdgcn_target "amdgcn-amd-amdhsa--gfx950"
.text
.globl mpnn_prep_kernel
.p2align 8
.type mpnn_prep_kernel,@function
mpnn_prep_kernel:
  s_cmp_ge_u32 s2, 295
  s_cbranch_scc1 K0_DONE
  s_load_dwordx4 s[4:7], s[0:1], 0
  s_load_dwordx4 s[8:11], s[0:1], 16
  s_load_dwordx4 s[12:15], s[0:1], 32
  s_load_dwordx2 s[16:17], s[0:1], 48
  s_load_dwordx2 s[18:19], s[0:1], 72
  s_waitcnt lgkmcnt(0)
  s_mov_b32 s20, s18
  s_and_b32 s21, s19, 0xffff
  s_mov_b32 s22, 15259424
  s_mov_b32 s23, 0x00020000
  s_cmp_lt_u32 s2, 196
  s_cbranch_scc1 K0_GEMM
  s_cmp_lt_u32 s2, 294
  s_cbranch_scc1 K0_BIN
  s_mov_b32 s24, s16
  s_and_b32 s25, s17, 0xffff
  s_mov_b32 s26, 69632
  s_mov_b32 s27, 0x00020000
  v_lshrrev_b32 v1, 4, v0
  v_and_b32 v2, 15, v0
  v_lshlrev_b32 v3, 8, v1
  v_lshl_add_u32 v3, v2, 1, v3
  v_add_u32 v3, 65536, v3
  buffer_load_ushort v8, v3, s[24:27], 0 offen offset:0
  buffer_load_ushort v9, v3, s[24:27], 0 offen offset:32
  buffer_load_ushort v10, v3, s[24:27], 0 offen offset:64
  buffer_load_ushort v11, v3, s[24:27], 0 offen offset:96
  buffer_load_ushort v12, v3, s[24:27], 0 offen offset:128
  buffer_load_ushort v13, v3, s[24:27], 0 offen offset:160
  buffer_load_ushort v14, v3, s[24:27], 0 offen offset:192
  buffer_load_ushort v15, v3, s[24:27], 0 offen offset:224
  s_mov_b32 s28, 3216550459
  v_lshlrev_b32 v4, 8, v1
  v_lshl_add_u32 v4, v2, 3, v4
  v_add_u32 v4, 9633792, v4
  s_waitcnt vmcnt(0)
  v_lshlrev_b32 v8, 16, v8
  v_mul_f32 v8, s28, v8
  v_lshlrev_b32 v9, 16, v9
  v_mul_f32 v9, s28, v9
  v_lshlrev_b32 v10, 16, v10
  v_mul_f32 v10, s28, v10
  v_lshlrev_b32 v11, 16, v11
  v_mul_f32 v11, s28, v11
  v_lshlrev_b32 v12, 16, v12
  v_mul_f32 v12, s28, v12
  v_lshlrev_b32 v13, 16, v13
  v_mul_f32 v13, s28, v13
  v_lshlrev_b32 v14, 16, v14
  v_mul_f32 v14, s28, v14
  v_lshlrev_b32 v15, 16, v15
  v_mul_f32 v15, s28, v15
  v_cvt_pk_bf16_f32 v16, v8, v9
  v_cvt_pk_bf16_f32 v17, v10, v11
  v_cvt_pk_bf16_f32 v18, v12, v13
  v_cvt_pk_bf16_f32 v19, v14, v15
  buffer_store_dwordx2 v[16:17], v4, s[20:23], 0 offen
  buffer_store_dwordx2 v[18:19], v4, s[20:23], 0 offen offset:128
  s_endpgm
K0_BIN:
  s_sub_u32 s3, s2, 196
  s_mov_b32 s24, s8
  s_and_b32 s25, s9, 0xffff
  s_mov_b32 s26, 1600000
  s_mov_b32 s27, 0x00020000
  s_mov_b32 s28, s10
  s_and_b32 s29, s11, 0xffff
  s_mov_b32 s30, 1600000
  s_mov_b32 s31, 0x00020000
  s_lshl_b32 s32, s3, 14
  v_lshlrev_b32 v1, 6, v0
  buffer_load_dwordx4 v[4:7], v1, s[28:31], s32 offen offset:0
  buffer_load_dwordx4 v[8:11], v1, s[28:31], s32 offen offset:16
  buffer_load_dwordx4 v[12:15], v1, s[28:31], s32 offen offset:32
  buffer_load_dwordx4 v[16:19], v1, s[28:31], s32 offen offset:48
  buffer_load_dwordx4 v[20:23], v1, s[24:27], s32 offen offset:0
  buffer_load_dwordx4 v[24:27], v1, s[24:27], s32 offen offset:16
  buffer_load_dwordx4 v[28:31], v1, s[24:27], s32 offen offset:32
  buffer_load_dwordx4 v[32:35], v1, s[24:27], s32 offen offset:48
  v_mov_b32 v100, 0
  v_mov_b32 v101, 0
  v_mov_b32 v102, 0
  v_mov_b32 v103, 0
  v_lshlrev_b32 v2, 4, v0
  ds_write_b128 v2, v[100:103]
  ds_write_b128 v2, v[100:103] offset:4096
  ds_write_b128 v2, v[100:103] offset:8192
  ds_write_b128 v2, v[100:103] offset:12288
  ds_write_b128 v2, v[100:103] offset:16384
  s_mov_b32 s42, 1374390
  s_lshl_b32 s33, s3, 12
  s_sub_u32 s33, 400000, s33
  s_min_u32 s33, s33, 4096
  s_lshr_b32 s34, s33, 4
  s_mov_b32 s35, 703687442
  s_movk_i32 s41, 6250
  v_mov_b32 v3, 1
  s_waitcnt lgkmcnt(0)
  s_barrier
  s_waitcnt vmcnt(0)
  v_cmp_gt_u32 vcc, s34, v0
  s_and_saveexec_b64 s[36:37], vcc
  s_cbranch_execz K0_B1
  v_lshrrev_b32 v36, 1, v4
  v_mul_hi_u32 v36, v36, s35
  v_mul_hi_u32 v68, v20, s42
  v_lshl_add_u32 v52, v36, 2, v68
  v_lshlrev_b32 v52, 2, v52
  ds_add_rtn_u32 v68, v52, v3
  v_lshrrev_b32 v37, 1, v5
  v_mul_hi_u32 v37, v37, s35
  v_mul_hi_u32 v69, v21, s42
  v_lshl_add_u32 v53, v37, 2, v69
  v_lshlrev_b32 v53, 2, v53
  ds_add_rtn_u32 v69, v53, v3
  v_lshrrev_b32 v38, 1, v6
  v_mul_hi_u32 v38, v38, s35
  v_mul_hi_u32 v70, v22, s42
  v_lshl_add_u32 v54, v38, 2, v70
  v_lshlrev_b32 v54, 2, v54
  ds_add_rtn_u32 v70, v54, v3
  v_lshrrev_b32 v39, 1, v7
  v_mul_hi_u32 v39, v39, s35
  v_mul_hi_u32 v71, v23, s42
  v_lshl_add_u32 v55, v39, 2, v71
  v_lshlrev_b32 v55, 2, v55
  ds_add_rtn_u32 v71, v55, v3
  v_lshrrev_b32 v40, 1, v8
  v_mul_hi_u32 v40, v40, s35
  v_mul_hi_u32 v72, v24, s42
  v_lshl_add_u32 v56, v40, 2, v72
  v_lshlrev_b32 v56, 2, v56
  ds_add_rtn_u32 v72, v56, v3
  v_lshrrev_b32 v41, 1, v9
  v_mul_hi_u32 v41, v41, s35
  v_mul_hi_u32 v73, v25, s42
  v_lshl_add_u32 v57, v41, 2, v73
  v_lshlrev_b32 v57, 2, v57
  ds_add_rtn_u32 v73, v57, v3
  v_lshrrev_b32 v42, 1, v10
  v_mul_hi_u32 v42, v42, s35
  v_mul_hi_u32 v74, v26, s42
  v_lshl_add_u32 v58, v42, 2, v74
  v_lshlrev_b32 v58, 2, v58
  ds_add_rtn_u32 v74, v58, v3
  v_lshrrev_b32 v43, 1, v11
  v_mul_hi_u32 v43, v43, s35
  v_mul_hi_u32 v75, v27, s42
  v_lshl_add_u32 v59, v43, 2, v75
  v_lshlrev_b32 v59, 2, v59
  ds_add_rtn_u32 v75, v59, v3
  v_lshrrev_b32 v44, 1, v12
  v_mul_hi_u32 v44, v44, s35
  v_mul_hi_u32 v76, v28, s42
  v_lshl_add_u32 v60, v44, 2, v76
  v_lshlrev_b32 v60, 2, v60
  ds_add_rtn_u32 v76, v60, v3
  v_lshrrev_b32 v45, 1, v13
  v_mul_hi_u32 v45, v45, s35
  v_mul_hi_u32 v77, v29, s42
  v_lshl_add_u32 v61, v45, 2, v77
  v_lshlrev_b32 v61, 2, v61
  ds_add_rtn_u32 v77, v61, v3
  v_lshrrev_b32 v46, 1, v14
  v_mul_hi_u32 v46, v46, s35
  v_mul_hi_u32 v78, v30, s42
  v_lshl_add_u32 v62, v46, 2, v78
  v_lshlrev_b32 v62, 2, v62
  ds_add_rtn_u32 v78, v62, v3
  v_lshrrev_b32 v47, 1, v15
  v_mul_hi_u32 v47, v47, s35
  v_mul_hi_u32 v79, v31, s42
  v_lshl_add_u32 v63, v47, 2, v79
  v_lshlrev_b32 v63, 2, v63
  ds_add_rtn_u32 v79, v63, v3
  v_lshrrev_b32 v48, 1, v16
  v_mul_hi_u32 v48, v48, s35
  v_mul_hi_u32 v80, v32, s42
  v_lshl_add_u32 v64, v48, 2, v80
  v_lshlrev_b32 v64, 2, v64
  ds_add_rtn_u32 v80, v64, v3
  v_lshrrev_b32 v49, 1, v17
  v_mul_hi_u32 v49, v49, s35
  v_mul_hi_u32 v81, v33, s42
  v_lshl_add_u32 v65, v49, 2, v81
  v_lshlrev_b32 v65, 2, v65
  ds_add_rtn_u32 v81, v65, v3
  v_lshrrev_b32 v50, 1, v18
  v_mul_hi_u32 v50, v50, s35
  v_mul_hi_u32 v82, v34, s42
  v_lshl_add_u32 v66, v50, 2, v82
  v_lshlrev_b32 v66, 2, v66
  ds_add_rtn_u32 v82, v66, v3
  v_lshrrev_b32 v51, 1, v19
  v_mul_hi_u32 v51, v51, s35
  v_mul_hi_u32 v83, v35, s42
  v_lshl_add_u32 v67, v51, 2, v83
  v_lshlrev_b32 v67, 2, v67
  ds_add_rtn_u32 v83, v67, v3
K0_B1:
  s_mov_b64 exec, s[36:37]
  s_waitcnt lgkmcnt(0)
  s_barrier
  v_lshlrev_b32 v1, 6, v0
  ds_read_b128 v[128:131], v1 offset:0
  ds_read_b128 v[132:135], v1 offset:16
  ds_read_b128 v[136:139], v1 offset:32
  ds_read_b128 v[140:143], v1 offset:48
  s_waitcnt lgkmcnt(0)
  v_mov_b32 v144, 0
  v_mov_b32 v145, v128
  v_add_u32 v146, v145, v129
  v_add_u32 v147, v146, v130
  v_add_u32 v148, v147, v131
  v_add_u32 v149, v148, v132
  v_add_u32 v150, v149, v133
  v_add_u32 v151, v150, v134
  v_add_u32 v152, v151, v135
  v_add_u32 v153, v152, v136
  v_add_u32 v154, v153, v137
  v_add_u32 v155, v154, v138
  v_add_u32 v156, v155, v139
  v_add_u32 v157, v156, v140
  v_add_u32 v158, v157, v141
  v_add_u32 v159, v158, v142
  v_add_u32 v112, v159, v143
  v_mov_b32 v113, v112
  v_mov_b32 v114, 0
  s_nop 1
  v_mov_b32_dpp v114, v113 row_shr:1 row_mask:0xf bank_mask:0xf
  v_add_u32 v113, v113, v114
  v_mov_b32 v114, 0
  s_nop 1
  v_mov_b32_dpp v114, v113 row_shr:2 row_mask:0xf bank_mask:0xf
  v_add_u32 v113, v113, v114
  v_mov_b32 v114, 0
  s_nop 1
  v_mov_b32_dpp v114, v113 row_shr:4 row_mask:0xf bank_mask:0xf
  v_add_u32 v113, v113, v114
  v_mov_b32 v114, 0
  s_nop 1
  v_mov_b32_dpp v114, v113 row_shr:8 row_mask:0xf bank_mask:0xf
  v_add_u32 v113, v113, v114
  v_mov_b32 v114, 0
  s_nop 1
  v_mov_b32_dpp v114, v113 row_bcast:15 row_mask:0xa bank_mask:0xf
  v_add_u32 v113, v113, v114
  v_mov_b32 v114, 0
  s_nop 1
  v_mov_b32_dpp v114, v113 row_bcast:31 row_mask:0xc bank_mask:0xf
  v_add_u32 v113, v113, v114
  v_lshrrev_b32 v115, 6, v0
  v_lshlrev_b32 v114, 2, v115
  v_and_b32 v116, 63, v0
  v_cmp_eq_u32 vcc, 63, v116
  s_and_saveexec_b64 s[38:39], vcc
  ds_write_b32 v114, v113 offset:16640
  s_mov_b64 exec, s[38:39]
  s_waitcnt lgkmcnt(0)
  s_barrier
  v_mov_b32 v116, 0
  ds_read_b128 v[116:119], v116 offset:16640
  s_waitcnt lgkmcnt(0)
  v_cmp_lt_u32 vcc, 0, v115
  s_nop 1
  v_cndmask_b32 v116, 0, v116, vcc
  v_cmp_lt_u32 vcc, 1, v115
  s_nop 1
  v_cndmask_b32 v117, 0, v117, vcc
  v_cmp_lt_u32 vcc, 2, v115
  s_nop 1
  v_cndmask_b32 v118, 0, v118, vcc
  v_add3_u32 v116, v116, v117, v118
  v_add_u32 v116, v116, v113
  v_sub_u32 v117, v116, v112
  v_add_u32 v144, v144, v117
  v_add_u32 v145, v145, v117
  v_add_u32 v146, v146, v117
  v_add_u32 v147, v147, v117
  v_add_u32 v148, v148, v117
  v_add_u32 v149, v149, v117
  v_add_u32 v150, v150, v117
  v_add_u32 v151, v151, v117
  v_add_u32 v152, v152, v117
  v_add_u32 v153, v153, v117
  v_add_u32 v154, v154, v117
  v_add_u32 v155, v155, v117
  v_add_u32 v156, v156, v117
  v_add_u32 v157, v157, v117
  v_add_u32 v158, v158, v117
  v_add_u32 v159, v159, v117
  ds_write_b128 v1, v[144:147] offset:0
  ds_write_b128 v1, v[148:151] offset:16
  ds_write_b128 v1, v[152:155] offset:32
  ds_write_b128 v1, v[156:159] offset:48
  s_mul_i32 s40, s3, 8208
  s_add_u32 s40, s40, 14454784
  v_lshl_or_b32 v128, v145, 16, v144
  v_lshl_or_b32 v129, v147, 16, v146
  v_lshl_or_b32 v130, v149, 16, v148
  v_lshl_or_b32 v131, v151, 16, v150
  v_lshl_or_b32 v132, v153, 16, v152
  v_lshl_or_b32 v133, v155, 16, v154
  v_lshl_or_b32 v134, v157, 16, v156
  v_lshl_or_b32 v135, v159, 16, v158
  v_lshlrev_b32 v114, 5, v0
  buffer_store_dwordx4 v[128:131], v114, s[20:23], s40 offen
  buffer_store_dwordx4 v[132:135], v114, s[20:23], s40 offen offset:16
  v_cmp_eq_u32 vcc, 255, v0
  s_and_saveexec_b64 s[38:39], vcc
  s_cbranch_execz K0_B2
  buffer_store_dword v116, v114, s[20:23], s40 offen offset:32
K0_B2:
  s_mov_b64 exec, s[38:39]
  s_waitcnt lgkmcnt(0)
  s_barrier
  s_mov_b64 exec, s[36:37]
  v_cmp_gt_u32 vcc, s34, v0
  s_and_saveexec_b64 s[36:37], vcc
  s_cbranch_execz K0_B3
  ds_read_b32 v84, v52
  ds_read_b32 v85, v53
  ds_read_b32 v86, v54
  ds_read_b32 v87, v55
  ds_read_b32 v88, v56
  ds_read_b32 v89, v57
  ds_read_b32 v90, v58
  ds_read_b32 v91, v59
  ds_read_b32 v92, v60
  ds_read_b32 v93, v61
  ds_read_b32 v94, v62
  ds_read_b32 v95, v63
  ds_read_b32 v96, v64
  ds_read_b32 v97, v65
  ds_read_b32 v98, v66
  ds_read_b32 v99, v67
  v_lshlrev_b32 v1, 4, v0
  v_mul_u32_u24 v36, s41, v36
  v_add_u32 v36, 1023, v36
  v_lshrrev_b32 v36, 10, v36
  v_lshlrev_b32 v36, 1, v36
  v_sub_u32 v36, v4, v36
  v_lshl_or_b32 v36, v20, 18, v36
  v_add_u32 v4, 0, v1
  v_lshl_or_b32 v36, v4, 6, v36
  v_mul_u32_u24 v37, s41, v37
  v_add_u32 v37, 1023, v37
  v_lshrrev_b32 v37, 10, v37
  v_lshlrev_b32 v37, 1, v37
  v_sub_u32 v37, v5, v37
  v_lshl_or_b32 v37, v21, 18, v37
  v_add_u32 v5, 1, v1
  v_lshl_or_b32 v37, v5, 6, v37
  v_mul_u32_u24 v38, s41, v38
  v_add_u32 v38, 1023, v38
  v_lshrrev_b32 v38, 10, v38
  v_lshlrev_b32 v38, 1, v38
  v_sub_u32 v38, v6, v38
  v_lshl_or_b32 v38, v22, 18, v38
  v_add_u32 v6, 2, v1
  v_lshl_or_b32 v38, v6, 6, v38
  v_mul_u32_u24 v39, s41, v39
  v_add_u32 v39, 1023, v39
  v_lshrrev_b32 v39, 10, v39
  v_lshlrev_b32 v39, 1, v39
  v_sub_u32 v39, v7, v39
  v_lshl_or_b32 v39, v23, 18, v39
  v_add_u32 v7, 3, v1
  v_lshl_or_b32 v39, v7, 6, v39
  v_mul_u32_u24 v40, s41, v40
  v_add_u32 v40, 1023, v40
  v_lshrrev_b32 v40, 10, v40
  v_lshlrev_b32 v40, 1, v40
  v_sub_u32 v40, v8, v40
  v_lshl_or_b32 v40, v24, 18, v40
  v_add_u32 v8, 4, v1
  v_lshl_or_b32 v40, v8, 6, v40
  v_mul_u32_u24 v41, s41, v41
  v_add_u32 v41, 1023, v41
  v_lshrrev_b32 v41, 10, v41
  v_lshlrev_b32 v41, 1, v41
  v_sub_u32 v41, v9, v41
  v_lshl_or_b32 v41, v25, 18, v41
  v_add_u32 v9, 5, v1
  v_lshl_or_b32 v41, v9, 6, v41
  v_mul_u32_u24 v42, s41, v42
  v_add_u32 v42, 1023, v42
  v_lshrrev_b32 v42, 10, v42
  v_lshlrev_b32 v42, 1, v42
  v_sub_u32 v42, v10, v42
  v_lshl_or_b32 v42, v26, 18, v42
  v_add_u32 v10, 6, v1
  v_lshl_or_b32 v42, v10, 6, v42
  v_mul_u32_u24 v43, s41, v43
  v_add_u32 v43, 1023, v43
  v_lshrrev_b32 v43, 10, v43
  v_lshlrev_b32 v43, 1, v43
  v_sub_u32 v43, v11, v43
  v_lshl_or_b32 v43, v27, 18, v43
  v_add_u32 v11, 7, v1
  v_lshl_or_b32 v43, v11, 6, v43
  v_mul_u32_u24 v44, s41, v44
  v_add_u32 v44, 1023, v44
  v_lshrrev_b32 v44, 10, v44
  v_lshlrev_b32 v44, 1, v44
  v_sub_u32 v44, v12, v44
  v_lshl_or_b32 v44, v28, 18, v44
  v_add_u32 v12, 8, v1
  v_lshl_or_b32 v44, v12, 6, v44
  v_mul_u32_u24 v45, s41, v45
  v_add_u32 v45, 1023, v45
  v_lshrrev_b32 v45, 10, v45
  v_lshlrev_b32 v45, 1, v45
  v_sub_u32 v45, v13, v45
  v_lshl_or_b32 v45, v29, 18, v45
  v_add_u32 v13, 9, v1
  v_lshl_or_b32 v45, v13, 6, v45
  v_mul_u32_u24 v46, s41, v46
  v_add_u32 v46, 1023, v46
  v_lshrrev_b32 v46, 10, v46
  v_lshlrev_b32 v46, 1, v46
  v_sub_u32 v46, v14, v46
  v_lshl_or_b32 v46, v30, 18, v46
  v_add_u32 v14, 10, v1
  v_lshl_or_b32 v46, v14, 6, v46
  v_mul_u32_u24 v47, s41, v47
  v_add_u32 v47, 1023, v47
  v_lshrrev_b32 v47, 10, v47
  v_lshlrev_b32 v47, 1, v47
  v_sub_u32 v47, v15, v47
  v_lshl_or_b32 v47, v31, 18, v47
  v_add_u32 v15, 11, v1
  v_lshl_or_b32 v47, v15, 6, v47
  v_mul_u32_u24 v48, s41, v48
  v_add_u32 v48, 1023, v48
  v_lshrrev_b32 v48, 10, v48
  v_lshlrev_b32 v48, 1, v48
  v_sub_u32 v48, v16, v48
  v_lshl_or_b32 v48, v32, 18, v48
  v_add_u32 v16, 12, v1
  v_lshl_or_b32 v48, v16, 6, v48
  v_mul_u32_u24 v49, s41, v49
  v_add_u32 v49, 1023, v49
  v_lshrrev_b32 v49, 10, v49
  v_lshlrev_b32 v49, 1, v49
  v_sub_u32 v49, v17, v49
  v_lshl_or_b32 v49, v33, 18, v49
  v_add_u32 v17, 13, v1
  v_lshl_or_b32 v49, v17, 6, v49
  v_mul_u32_u24 v50, s41, v50
  v_add_u32 v50, 1023, v50
  v_lshrrev_b32 v50, 10, v50
  v_lshlrev_b32 v50, 1, v50
  v_sub_u32 v50, v18, v50
  v_lshl_or_b32 v50, v34, 18, v50
  v_add_u32 v18, 14, v1
  v_lshl_or_b32 v50, v18, 6, v50
  v_mul_u32_u24 v51, s41, v51
  v_add_u32 v51, 1023, v51
  v_lshrrev_b32 v51, 10, v51
  v_lshlrev_b32 v51, 1, v51
  v_sub_u32 v51, v19, v51
  v_lshl_or_b32 v51, v35, 18, v51
  v_add_u32 v19, 15, v1
  v_lshl_or_b32 v51, v19, 6, v51
  s_waitcnt lgkmcnt(0)
  v_add_lshl_u32 v84, v84, v68, 2
  ds_write_b32 v84, v36 offset:16896
  v_add_lshl_u32 v85, v85, v69, 2
  ds_write_b32 v85, v37 offset:16896
  v_add_lshl_u32 v86, v86, v70, 2
  ds_write_b32 v86, v38 offset:16896
  v_add_lshl_u32 v87, v87, v71, 2
  ds_write_b32 v87, v39 offset:16896
  v_add_lshl_u32 v88, v88, v72, 2
  ds_write_b32 v88, v40 offset:16896
  v_add_lshl_u32 v89, v89, v73, 2
  ds_write_b32 v89, v41 offset:16896
  v_add_lshl_u32 v90, v90, v74, 2
  ds_write_b32 v90, v42 offset:16896
  v_add_lshl_u32 v91, v91, v75, 2
  ds_write_b32 v91, v43 offset:16896
  v_add_lshl_u32 v92, v92, v76, 2
  ds_write_b32 v92, v44 offset:16896
  v_add_lshl_u32 v93, v93, v77, 2
  ds_write_b32 v93, v45 offset:16896
  v_add_lshl_u32 v94, v94, v78, 2
  ds_write_b32 v94, v46 offset:16896
  v_add_lshl_u32 v95, v95, v79, 2
  ds_write_b32 v95, v47 offset:16896
  v_add_lshl_u32 v96, v96, v80, 2
  ds_write_b32 v96, v48 offset:16896
  v_add_lshl_u32 v97, v97, v81, 2
  ds_write_b32 v97, v49 offset:16896
  v_add_lshl_u32 v98, v98, v82, 2
  ds_write_b32 v98, v50 offset:16896
  v_add_lshl_u32 v99, v99, v83, 2
  ds_write_b32 v99, v51 offset:16896
K0_B3:
  s_mov_b64 exec, s[36:37]
  s_waitcnt lgkmcnt(0)
  s_barrier
  v_lshlrev_b32 v1, 4, v0
  ds_read_b128 v[4:7], v1 offset:16896
  ds_read_b128 v[8:11], v1 offset:20992
  ds_read_b128 v[12:15], v1 offset:25088
  ds_read_b128 v[16:19], v1 offset:29184
  s_add_u32 s32, s32, 12849152
  s_waitcnt lgkmcnt(0)
  buffer_store_dwordx4 v[4:7], v1, s[20:23], s32 offen
  s_add_u32 s32, s32, 4096
  buffer_store_dwordx4 v[8:11], v1, s[20:23], s32 offen
  s_add_u32 s32, s32, 4096
  buffer_store_dwordx4 v[12:15], v1, s[20:23], s32 offen
  s_add_u32 s32, s32, 4096
  buffer_store_dwordx4 v[16:19], v1, s[20:23], s32 offen
  s_add_u32 s32, s32, 4096
  s_endpgm
K0_GEMM:
  s_and_b32 s3, s2, 1
  s_lshr_b32 s33, s2, 1
  s_lshl_b32 s34, s3, 15
  s_add_u32 s16, s16, s34
  s_addc_u32 s17, s17, 0
  s_mov_b32 s24, s16
  s_and_b32 s25, s17, 0xffff
  s_mov_b32 s26, 32768
  s_mov_b32 s27, 0x00020000
  s_cmp_eq_u32 s3, 0
  s_cselect_b32 s34, s12, s14
  s_cselect_b32 s35, s13, s15
  s_mov_b32 s28, s34
  s_and_b32 s29, s35, 0xffff
  s_mov_b32 s30, 32768
  s_mov_b32 s31, 0x00020000
  s_mov_b32 s36, s4
  s_and_b32 s37, s5, 0xffff
  s_mov_b32 s38, 3200000
  s_mov_b32 s39, 0x00020000
  v_lshlrev_b32 v1, 4, v0
  s_mov_b32 s40, 0
  buffer_load_dwordx4 v[64:67], v1, s[24:27], s40 offen
  s_mov_b32 s40, 4096
  buffer_load_dwordx4 v[68:71], v1, s[24:27], s40 offen
  s_mov_b32 s40, 8192
  buffer_load_dwordx4 v[72:75], v1, s[24:27], s40 offen
  s_mov_b32 s40, 12288
  buffer_load_dwordx4 v[76:79], v1, s[24:27], s40 offen
  s_mov_b32 s40, 16384
  buffer_load_dwordx4 v[80:83], v1, s[24:27], s40 offen
  s_mov_b32 s40, 20480
  buffer_load_dwordx4 v[84:87], v1, s[24:27], s40 offen
  s_mov_b32 s40, 24576
  buffer_load_dwordx4 v[88:91], v1, s[24:27], s40 offen
  s_mov_b32 s40, 28672
  buffer_load_dwordx4 v[92:95], v1, s[24:27], s40 offen
  s_mov_b32 s40, 0
  buffer_load_dwordx4 v[96:99], v1, s[28:31], s40 offen
  s_mov_b32 s40, 4096
  buffer_load_dwordx4 v[100:103], v1, s[28:31], s40 offen
  s_mov_b32 s40, 8192
  buffer_load_dwordx4 v[104:107], v1, s[28:31], s40 offen
  s_mov_b32 s40, 12288
  buffer_load_dwordx4 v[108:111], v1, s[28:31], s40 offen
  s_mov_b32 s40, 16384
  buffer_load_dwordx4 v[112:115], v1, s[28:31], s40 offen
  s_mov_b32 s40, 20480
  buffer_load_dwordx4 v[116:119], v1, s[28:31], s40 offen
  s_mov_b32 s40, 24576
  buffer_load_dwordx4 v[120:123], v1, s[28:31], s40 offen
  s_mov_b32 s40, 28672
  buffer_load_dwordx4 v[124:127], v1, s[28:31], s40 offen
  v_and_b32 v2, 15, v0
  v_bfe_u32 v3, v0, 4, 2
  v_lshrrev_b32 v4, 6, v0
  s_lshl_b32 s41, s33, 7
  v_lshlrev_b32 v5, 5, v4
  v_add3_u32 v5, v5, v2, s41
  v_lshlrev_b32 v6, 8, v5
  v_lshl_add_u32 v6, v3, 4, v6
  v_add_u32 v7, 4096, v6
  buffer_load_dwordx4 v[32:35], v6, s[36:39], 0 offen offset:0
  buffer_load_dwordx4 v[36:39], v6, s[36:39], 0 offen offset:64
  buffer_load_dwordx4 v[40:43], v6, s[36:39], 0 offen offset:128
  buffer_load_dwordx4 v[44:47], v6, s[36:39], 0 offen offset:192
  buffer_load_dwordx4 v[48:51], v7, s[36:39], 0 offen offset:0
  buffer_load_dwordx4 v[52:55], v7, s[36:39], 0 offen offset:64
  buffer_load_dwordx4 v[56:59], v7, s[36:39], 0 offen offset:128
  buffer_load_dwordx4 v[60:63], v7, s[36:39], 0 offen offset:192
  v_lshrrev_b32 v8, 4, v0
  v_mul_u32_u24 v8, 288, v8
  v_lshl_add_u32 v8, v2, 4, v8
  v_add_u32 v9, 36864, v8
  s_waitcnt vmcnt(16)
  ds_write_b128 v8, v[64:67] offset:0
  ds_write_b128 v8, v[68:71] offset:4608
  ds_write_b128 v8, v[72:75] offset:9216
  ds_write_b128 v8, v[76:79] offset:13824
  ds_write_b128 v8, v[80:83] offset:18432
  ds_write_b128 v8, v[84:87] offset:23040
  ds_write_b128 v8, v[88:91] offset:27648
  ds_write_b128 v8, v[92:95] offset:32256
  s_waitcnt vmcnt(8)
  ds_write_b128 v9, v[96:99] offset:0
  ds_write_b128 v9, v[100:103] offset:4608
  ds_write_b128 v9, v[104:107] offset:9216
  ds_write_b128 v9, v[108:111] offset:13824
  ds_write_b128 v9, v[112:115] offset:18432
  ds_write_b128 v9, v[116:119] offset:23040
  ds_write_b128 v9, v[120:123] offset:27648
  ds_write_b128 v9, v[124:127] offset:32256
  v_lshrrev_b32 v10, 2, v2
  v_lshl_add_u32 v10, v3, 3, v10
  v_mul_u32_u24 v10, 288, v10
  v_and_b32 v11, 3, v2
  v_lshl_add_u32 v10, v11, 3, v10
  v_add_u32 v11, 36864, v10
  s_mov_b32 s42, 3216550459
  v_lshlrev_b32 v12, 5, v4
  v_lshl_add_u32 v12, v3, 2, v12
  v_add_u32 v12, s41, v12
  s_waitcnt lgkmcnt(0)
  s_barrier
  ds_read_b64_tr_b16 v[64:65], v10 offset:0
  ds_read_b64_tr_b16 v[66:67], v10 offset:1152
  ds_read_b64_tr_b16 v[68:69], v10 offset:9216
  ds_read_b64_tr_b16 v[70:71], v10 offset:10368
  ds_read_b64_tr_b16 v[72:73], v10 offset:18432
  ds_read_b64_tr_b16 v[74:75], v10 offset:19584
  ds_read_b64_tr_b16 v[76:77], v10 offset:27648
  ds_read_b64_tr_b16 v[78:79], v10 offset:28800
  ds_read_b64_tr_b16 v[80:81], v10 offset:32
  ds_read_b64_tr_b16 v[82:83], v10 offset:1184
  ds_read_b64_tr_b16 v[84:85], v10 offset:9248
  ds_read_b64_tr_b16 v[86:87], v10 offset:10400
  ds_read_b64_tr_b16 v[88:89], v10 offset:18464
  ds_read_b64_tr_b16 v[90:91], v10 offset:19616
  ds_read_b64_tr_b16 v[92:93], v10 offset:27680
  ds_read_b64_tr_b16 v[94:95], v10 offset:28832
  ds_read_b64_tr_b16 v[96:97], v10 offset:64
  ds_read_b64_tr_b16 v[98:99], v10 offset:1216
  ds_read_b64_tr_b16 v[100:101], v10 offset:9280
  ds_read_b64_tr_b16 v[102:103], v10 offset:10432
  ds_read_b64_tr_b16 v[104:105], v10 offset:18496
  ds_read_b64_tr_b16 v[106:107], v10 offset:19648
  ds_read_b64_tr_b16 v[108:109], v10 offset:27712
  ds_read_b64_tr_b16 v[110:111], v10 offset:28864
  ds_read_b64_tr_b16 v[112:113], v10 offset:96
  ds_read_b64_tr_b16 v[114:115], v10 offset:1248
  ds_read_b64_tr_b16 v[116:117], v10 offset:9312
  ds_read_b64_tr_b16 v[118:119], v10 offset:10464
  ds_read_b64_tr_b16 v[120:121], v10 offset:18528
  ds_read_b64_tr_b16 v[122:123], v10 offset:19680
  ds_read_b64_tr_b16 v[124:125], v10 offset:27744
  ds_read_b64_tr_b16 v[126:127], v10 offset:28896
  s_waitcnt vmcnt(0)
  s_cmp_eq_u32 s3, 1
  s_cbranch_scc1 K0_GEMM1
  v_lshlrev_b32 v14, 8, v12
  v_lshl_add_u32 v14, v2, 3, v14
  v_add_u32 v15, 4096, v14
  s_mov_b32 s44, 6422528
  s_mov_b32 s45, 9637888
  s_waitcnt lgkmcnt(0)
  v_mfma_f32_16x16x32_bf16 v[128:131], v[32:35], v[64:67], 0
  v_mfma_f32_16x16x32_bf16 v[132:135], v[32:35], v[80:83], 0
  v_mfma_f32_16x16x32_bf16 v[136:139], v[32:35], v[96:99], 0
  v_mfma_f32_16x16x32_bf16 v[140:143], v[32:35], v[112:115], 0
  v_mfma_f32_16x16x32_bf16 v[144:147], v[48:51], v[64:67], 0
  v_mfma_f32_16x16x32_bf16 v[148:151], v[48:51], v[80:83], 0
  v_mfma_f32_16x16x32_bf16 v[152:155], v[48:51], v[96:99], 0
  v_mfma_f32_16x16x32_bf16 v[156:159], v[48:51], v[112:115], 0
  v_mfma_f32_16x16x32_bf16 v[128:131], v[36:39], v[68:71], v[128:131]
  v_mfma_f32_16x16x32_bf16 v[132:135], v[36:39], v[84:87], v[132:135]
  v_mfma_f32_16x16x32_bf16 v[136:139], v[36:39], v[100:103], v[136:139]
  v_mfma_f32_16x16x32_bf16 v[140:143], v[36:39], v[116:119], v[140:143]
  v_mfma_f32_16x16x32_bf16 v[144:147], v[52:55], v[68:71], v[144:147]
  v_mfma_f32_16x16x32_bf16 v[148:151], v[52:55], v[84:87], v[148:151]
  v_mfma_f32_16x16x32_bf16 v[152:155], v[52:55], v[100:103], v[152:155]
  v_mfma_f32_16x16x32_bf16 v[156:159], v[52:55], v[116:119], v[156:159]
  v_mfma_f32_16x16x32_bf16 v[128:131], v[40:43], v[72:75], v[128:131]
  v_mfma_f32_16x16x32_bf16 v[132:135], v[40:43], v[88:91], v[132:135]
  v_mfma_f32_16x16x32_bf16 v[136:139], v[40:43], v[104:107], v[136:139]
  v_mfma_f32_16x16x32_bf16 v[140:143], v[40:43], v[120:123], v[140:143]
  v_mfma_f32_16x16x32_bf16 v[144:147], v[56:59], v[72:75], v[144:147]
  v_mfma_f32_16x16x32_bf16 v[148:151], v[56:59], v[88:91], v[148:151]
  v_mfma_f32_16x16x32_bf16 v[152:155], v[56:59], v[104:107], v[152:155]
  v_mfma_f32_16x16x32_bf16 v[156:159], v[56:59], v[120:123], v[156:159]
  v_mfma_f32_16x16x32_bf16 v[128:131], v[44:47], v[76:79], v[128:131]
  v_mfma_f32_16x16x32_bf16 v[132:135], v[44:47], v[92:95], v[132:135]
  v_mfma_f32_16x16x32_bf16 v[136:139], v[44:47], v[108:111], v[136:139]
  v_mfma_f32_16x16x32_bf16 v[140:143], v[44:47], v[124:127], v[140:143]
  v_mfma_f32_16x16x32_bf16 v[144:147], v[60:63], v[76:79], v[144:147]
  v_mfma_f32_16x16x32_bf16 v[148:151], v[60:63], v[92:95], v[148:151]
  v_mfma_f32_16x16x32_bf16 v[152:155], v[60:63], v[108:111], v[152:155]
  v_mfma_f32_16x16x32_bf16 v[156:159], v[60:63], v[124:127], v[156:159]
  s_nop 7
  s_nop 1
  ds_read_b64_tr_b16 v[64:65], v11 offset:0
  ds_read_b64_tr_b16 v[66:67], v11 offset:1152
  ds_read_b64_tr_b16 v[68:69], v11 offset:9216
  ds_read_b64_tr_b16 v[70:71], v11 offset:10368
  ds_read_b64_tr_b16 v[72:73], v11 offset:18432
  ds_read_b64_tr_b16 v[74:75], v11 offset:19584
  ds_read_b64_tr_b16 v[76:77], v11 offset:27648
  ds_read_b64_tr_b16 v[78:79], v11 offset:28800
  ds_read_b64_tr_b16 v[80:81], v11 offset:32
  ds_read_b64_tr_b16 v[82:83], v11 offset:1184
  ds_read_b64_tr_b16 v[84:85], v11 offset:9248
  ds_read_b64_tr_b16 v[86:87], v11 offset:10400
  ds_read_b64_tr_b16 v[88:89], v11 offset:18464
  ds_read_b64_tr_b16 v[90:91], v11 offset:19616
  ds_read_b64_tr_b16 v[92:93], v11 offset:27680
  ds_read_b64_tr_b16 v[94:95], v11 offset:28832
  ds_read_b64_tr_b16 v[96:97], v11 offset:64
  ds_read_b64_tr_b16 v[98:99], v11 offset:1216
  ds_read_b64_tr_b16 v[100:101], v11 offset:9280
  ds_read_b64_tr_b16 v[102:103], v11 offset:10432
  ds_read_b64_tr_b16 v[104:105], v11 offset:18496
  ds_read_b64_tr_b16 v[106:107], v11 offset:19648
  ds_read_b64_tr_b16 v[108:109], v11 offset:27712
  ds_read_b64_tr_b16 v[110:111], v11 offset:28864
  ds_read_b64_tr_b16 v[112:113], v11 offset:96
  ds_read_b64_tr_b16 v[114:115], v11 offset:1248
  ds_read_b64_tr_b16 v[116:117], v11 offset:9312
  ds_read_b64_tr_b16 v[118:119], v11 offset:10464
  ds_read_b64_tr_b16 v[120:121], v11 offset:18528
  ds_read_b64_tr_b16 v[122:123], v11 offset:19680
  ds_read_b64_tr_b16 v[124:125], v11 offset:27744
  ds_read_b64_tr_b16 v[126:127], v11 offset:28896
  v_mul_f32 v128, s42, v128
  v_mul_f32 v129, s42, v129
  v_mul_f32 v130, s42, v130
  v_mul_f32 v131, s42, v131
  v_mul_f32 v132, s42, v132
  v_mul_f32 v133, s42, v133
  v_mul_f32 v134, s42, v134
  v_mul_f32 v135, s42, v135
  v_mul_f32 v136, s42, v136
  v_mul_f32 v137, s42, v137
  v_mul_f32 v138, s42, v138
  v_mul_f32 v139, s42, v139
  v_mul_f32 v140, s42, v140
  v_mul_f32 v141, s42, v141
  v_mul_f32 v142, s42, v142
  v_mul_f32 v143, s42, v143
  v_mul_f32 v144, s42, v144
  v_mul_f32 v145, s42, v145
  v_mul_f32 v146, s42, v146
  v_mul_f32 v147, s42, v147
  v_mul_f32 v148, s42, v148
  v_mul_f32 v149, s42, v149
  v_mul_f32 v150, s42, v150
  v_mul_f32 v151, s42, v151
  v_mul_f32 v152, s42, v152
  v_mul_f32 v153, s42, v153
  v_mul_f32 v154, s42, v154
  v_mul_f32 v155, s42, v155
  v_mul_f32 v156, s42, v156
  v_mul_f32 v157, s42, v157
  v_mul_f32 v158, s42, v158
  v_mul_f32 v159, s42, v159
  v_cvt_pk_bf16_f32 v160, v128, v132
  v_cvt_pk_bf16_f32 v161, v136, v140
  v_cvt_pk_bf16_f32 v162, v129, v133
  v_cvt_pk_bf16_f32 v163, v137, v141
  v_cvt_pk_bf16_f32 v164, v130, v134
  v_cvt_pk_bf16_f32 v165, v138, v142
  v_cvt_pk_bf16_f32 v166, v131, v135
  v_cvt_pk_bf16_f32 v167, v139, v143
  v_cvt_pk_bf16_f32 v168, v144, v148
  v_cvt_pk_bf16_f32 v169, v152, v156
  v_cvt_pk_bf16_f32 v170, v145, v149
  v_cvt_pk_bf16_f32 v171, v153, v157
  v_cvt_pk_bf16_f32 v172, v146, v150
  v_cvt_pk_bf16_f32 v173, v154, v158
  v_cvt_pk_bf16_f32 v174, v147, v151
  v_cvt_pk_bf16_f32 v175, v155, v159
  buffer_store_dwordx2 v[160:161], v14, s[20:23], s44 offen offset:0 sc0 sc1
  buffer_store_dwordx2 v[162:163], v14, s[20:23], s44 offen offset:256 sc0 sc1
  buffer_store_dwordx2 v[164:165], v14, s[20:23], s44 offen offset:512 sc0 sc1
  buffer_store_dwordx2 v[166:167], v14, s[20:23], s44 offen offset:768 sc0 sc1
  buffer_store_dwordx2 v[168:169], v15, s[20:23], s44 offen offset:0 sc0 sc1
  buffer_store_dwordx2 v[170:171], v15, s[20:23], s44 offen offset:256 sc0 sc1
  buffer_store_dwordx2 v[172:173], v15, s[20:23], s44 offen offset:512 sc0 sc1
  buffer_store_dwordx2 v[174:175], v15, s[20:23], s44 offen offset:768 sc0 sc1
  s_waitcnt lgkmcnt(0)
  v_mfma_f32_16x16x32_bf16 v[128:131], v[32:35], v[64:67], 0
  v_mfma_f32_16x16x32_bf16 v[132:135], v[32:35], v[80:83], 0
  v_mfma_f32_16x16x32_bf16 v[136:139], v[32:35], v[96:99], 0
  v_mfma_f32_16x16x32_bf16 v[140:143], v[32:35], v[112:115], 0
  v_mfma_f32_16x16x32_bf16 v[144:147], v[48:51], v[64:67], 0
  v_mfma_f32_16x16x32_bf16 v[148:151], v[48:51], v[80:83], 0
  v_mfma_f32_16x16x32_bf16 v[152:155], v[48:51], v[96:99], 0
  v_mfma_f32_16x16x32_bf16 v[156:159], v[48:51], v[112:115], 0
  v_mfma_f32_16x16x32_bf16 v[128:131], v[36:39], v[68:71], v[128:131]
  v_mfma_f32_16x16x32_bf16 v[132:135], v[36:39], v[84:87], v[132:135]
  v_mfma_f32_16x16x32_bf16 v[136:139], v[36:39], v[100:103], v[136:139]
  v_mfma_f32_16x16x32_bf16 v[140:143], v[36:39], v[116:119], v[140:143]
  v_mfma_f32_16x16x32_bf16 v[144:147], v[52:55], v[68:71], v[144:147]
  v_mfma_f32_16x16x32_bf16 v[148:151], v[52:55], v[84:87], v[148:151]
  v_mfma_f32_16x16x32_bf16 v[152:155], v[52:55], v[100:103], v[152:155]
  v_mfma_f32_16x16x32_bf16 v[156:159], v[52:55], v[116:119], v[156:159]
  v_mfma_f32_16x16x32_bf16 v[128:131], v[40:43], v[72:75], v[128:131]
  v_mfma_f32_16x16x32_bf16 v[132:135], v[40:43], v[88:91], v[132:135]
  v_mfma_f32_16x16x32_bf16 v[136:139], v[40:43], v[104:107], v[136:139]
  v_mfma_f32_16x16x32_bf16 v[140:143], v[40:43], v[120:123], v[140:143]
  v_mfma_f32_16x16x32_bf16 v[144:147], v[56:59], v[72:75], v[144:147]
  v_mfma_f32_16x16x32_bf16 v[148:151], v[56:59], v[88:91], v[148:151]
  v_mfma_f32_16x16x32_bf16 v[152:155], v[56:59], v[104:107], v[152:155]
  v_mfma_f32_16x16x32_bf16 v[156:159], v[56:59], v[120:123], v[156:159]
  v_mfma_f32_16x16x32_bf16 v[128:131], v[44:47], v[76:79], v[128:131]
  v_mfma_f32_16x16x32_bf16 v[132:135], v[44:47], v[92:95], v[132:135]
  v_mfma_f32_16x16x32_bf16 v[136:139], v[44:47], v[108:111], v[136:139]
  v_mfma_f32_16x16x32_bf16 v[140:143], v[44:47], v[124:127], v[140:143]
  v_mfma_f32_16x16x32_bf16 v[144:147], v[60:63], v[76:79], v[144:147]
  v_mfma_f32_16x16x32_bf16 v[148:151], v[60:63], v[92:95], v[148:151]
  v_mfma_f32_16x16x32_bf16 v[152:155], v[60:63], v[108:111], v[152:155]
  v_mfma_f32_16x16x32_bf16 v[156:159], v[60:63], v[124:127], v[156:159]
  s_nop 7
  s_nop 1
  ds_read_b64_tr_b16 v[64:65], v10 offset:128
  ds_read_b64_tr_b16 v[66:67], v10 offset:1280
  ds_read_b64_tr_b16 v[68:69], v10 offset:9344
  ds_read_b64_tr_b16 v[70:71], v10 offset:10496
  ds_read_b64_tr_b16 v[72:73], v10 offset:18560
  ds_read_b64_tr_b16 v[74:75], v10 offset:19712
  ds_read_b64_tr_b16 v[76:77], v10 offset:27776
  ds_read_b64_tr_b16 v[78:79], v10 offset:28928
  ds_read_b64_tr_b16 v[80:81], v10 offset:160
  ds_read_b64_tr_b16 v[82:83], v10 offset:1312
  ds_read_b64_tr_b16 v[84:85], v10 offset:9376
  ds_read_b64_tr_b16 v[86:87], v10 offset:10528
  ds_read_b64_tr_b16 v[88:89], v10 offset:18592
  ds_read_b64_tr_b16 v[90:91], v10 offset:19744
  ds_read_b64_tr_b16 v[92:93], v10 offset:27808
  ds_read_b64_tr_b16 v[94:95], v10 offset:28960
  ds_read_b64_tr_b16 v[96:97], v10 offset:192
  ds_read_b64_tr_b16 v[98:99], v10 offset:1344
  ds_read_b64_tr_b16 v[100:101], v10 offset:9408
  ds_read_b64_tr_b16 v[102:103], v10 offset:10560
  ds_read_b64_tr_b16 v[104:105], v10 offset:18624
  ds_read_b64_tr_b16 v[106:107], v10 offset:19776
  ds_read_b64_tr_b16 v[108:109], v10 offset:27840
  ds_read_b64_tr_b16 v[110:111], v10 offset:28992
  ds_read_b64_tr_b16 v[112:113], v10 offset:224
  ds_read_b64_tr_b16 v[114:115], v10 offset:1376
  ds_read_b64_tr_b16 v[116:117], v10 offset:9440
  ds_read_b64_tr_b16 v[118:119], v10 offset:10592
  ds_read_b64_tr_b16 v[120:121], v10 offset:18656
  ds_read_b64_tr_b16 v[122:123], v10 offset:19808
  ds_read_b64_tr_b16 v[124:125], v10 offset:27872
  ds_read_b64_tr_b16 v[126:127], v10 offset:29024
  v_cvt_pk_bf16_f32 v176, v128, v132
  v_cvt_pk_bf16_f32 v177, v136, v140
  v_cvt_pk_bf16_f32 v178, v129, v133
  v_cvt_pk_bf16_f32 v179, v137, v141
  v_cvt_pk_bf16_f32 v180, v130, v134
  v_cvt_pk_bf16_f32 v181, v138, v142
  v_cvt_pk_bf16_f32 v182, v131, v135
  v_cvt_pk_bf16_f32 v183, v139, v143
  v_cvt_pk_bf16_f32 v184, v144, v148
  v_cvt_pk_bf16_f32 v185, v152, v156
  v_cvt_pk_bf16_f32 v186, v145, v149
  v_cvt_pk_bf16_f32 v187, v153, v157
  v_cvt_pk_bf16_f32 v188, v146, v150
  v_cvt_pk_bf16_f32 v189, v154, v158
  v_cvt_pk_bf16_f32 v190, v147, v151
  v_cvt_pk_bf16_f32 v191, v155, v159
  buffer_store_dwordx2 v[176:177], v14, s[20:23], s45 offen offset:0 sc0 sc1
  buffer_store_dwordx2 v[178:179], v14, s[20:23], s45 offen offset:256 sc0 sc1
  buffer_store_dwordx2 v[180:181], v14, s[20:23], s45 offen offset:512 sc0 sc1
  buffer_store_dwordx2 v[182:183], v14, s[20:23], s45 offen offset:768 sc0 sc1
  buffer_store_dwordx2 v[184:185], v15, s[20:23], s45 offen offset:0 sc0 sc1
  buffer_store_dwordx2 v[186:187], v15, s[20:23], s45 offen offset:256 sc0 sc1
  buffer_store_dwordx2 v[188:189], v15, s[20:23], s45 offen offset:512 sc0 sc1
  buffer_store_dwordx2 v[190:191], v15, s[20:23], s45 offen offset:768 sc0 sc1
  s_waitcnt lgkmcnt(0)
  v_mfma_f32_16x16x32_bf16 v[128:131], v[32:35], v[64:67], 0
  v_mfma_f32_16x16x32_bf16 v[132:135], v[32:35], v[80:83], 0
  v_mfma_f32_16x16x32_bf16 v[136:139], v[32:35], v[96:99], 0
  v_mfma_f32_16x16x32_bf16 v[140:143], v[32:35], v[112:115], 0
  v_mfma_f32_16x16x32_bf16 v[144:147], v[48:51], v[64:67], 0
  v_mfma_f32_16x16x32_bf16 v[148:151], v[48:51], v[80:83], 0
  v_mfma_f32_16x16x32_bf16 v[152:155], v[48:51], v[96:99], 0
  v_mfma_f32_16x16x32_bf16 v[156:159], v[48:51], v[112:115], 0
  v_mfma_f32_16x16x32_bf16 v[128:131], v[36:39], v[68:71], v[128:131]
  v_mfma_f32_16x16x32_bf16 v[132:135], v[36:39], v[84:87], v[132:135]
  v_mfma_f32_16x16x32_bf16 v[136:139], v[36:39], v[100:103], v[136:139]
  v_mfma_f32_16x16x32_bf16 v[140:143], v[36:39], v[116:119], v[140:143]
  v_mfma_f32_16x16x32_bf16 v[144:147], v[52:55], v[68:71], v[144:147]
  v_mfma_f32_16x16x32_bf16 v[148:151], v[52:55], v[84:87], v[148:151]
  v_mfma_f32_16x16x32_bf16 v[152:155], v[52:55], v[100:103], v[152:155]
  v_mfma_f32_16x16x32_bf16 v[156:159], v[52:55], v[116:119], v[156:159]
  v_mfma_f32_16x16x32_bf16 v[128:131], v[40:43], v[72:75], v[128:131]
  v_mfma_f32_16x16x32_bf16 v[132:135], v[40:43], v[88:91], v[132:135]
  v_mfma_f32_16x16x32_bf16 v[136:139], v[40:43], v[104:107], v[136:139]
  v_mfma_f32_16x16x32_bf16 v[140:143], v[40:43], v[120:123], v[140:143]
  v_mfma_f32_16x16x32_bf16 v[144:147], v[56:59], v[72:75], v[144:147]
  v_mfma_f32_16x16x32_bf16 v[148:151], v[56:59], v[88:91], v[148:151]
  v_mfma_f32_16x16x32_bf16 v[152:155], v[56:59], v[104:107], v[152:155]
  v_mfma_f32_16x16x32_bf16 v[156:159], v[56:59], v[120:123], v[156:159]
  v_mfma_f32_16x16x32_bf16 v[128:131], v[44:47], v[76:79], v[128:131]
  v_mfma_f32_16x16x32_bf16 v[132:135], v[44:47], v[92:95], v[132:135]
  v_mfma_f32_16x16x32_bf16 v[136:139], v[44:47], v[108:111], v[136:139]
  v_mfma_f32_16x16x32_bf16 v[140:143], v[44:47], v[124:127], v[140:143]
  v_mfma_f32_16x16x32_bf16 v[144:147], v[60:63], v[76:79], v[144:147]
  v_mfma_f32_16x16x32_bf16 v[148:151], v[60:63], v[92:95], v[148:151]
  v_mfma_f32_16x16x32_bf16 v[152:155], v[60:63], v[108:111], v[152:155]
  v_mfma_f32_16x16x32_bf16 v[156:159], v[60:63], v[124:127], v[156:159]
  s_nop 7
  s_nop 1
  ds_read_b64_tr_b16 v[64:65], v11 offset:128
  ds_read_b64_tr_b16 v[66:67], v11 offset:1280
  ds_read_b64_tr_b16 v[68:69], v11 offset:9344
  ds_read_b64_tr_b16 v[70:71], v11 offset:10496
  ds_read_b64_tr_b16 v[72:73], v11 offset:18560
  ds_read_b64_tr_b16 v[74:75], v11 offset:19712
  ds_read_b64_tr_b16 v[76:77], v11 offset:27776
  ds_read_b64_tr_b16 v[78:79], v11 offset:28928
  ds_read_b64_tr_b16 v[80:81], v11 offset:160
  ds_read_b64_tr_b16 v[82:83], v11 offset:1312
  ds_read_b64_tr_b16 v[84:85], v11 offset:9376
  ds_read_b64_tr_b16 v[86:87], v11 offset:10528
  ds_read_b64_tr_b16 v[88:89], v11 offset:18592
  ds_read_b64_tr_b16 v[90:91], v11 offset:19744
  ds_read_b64_tr_b16 v[92:93], v11 offset:27808
  ds_read_b64_tr_b16 v[94:95], v11 offset:28960
  ds_read_b64_tr_b16 v[96:97], v11 offset:192
  ds_read_b64_tr_b16 v[98:99], v11 offset:1344
  ds_read_b64_tr_b16 v[100:101], v11 offset:9408
  ds_read_b64_tr_b16 v[102:103], v11 offset:10560
  ds_read_b64_tr_b16 v[104:105], v11 offset:18624
  ds_read_b64_tr_b16 v[106:107], v11 offset:19776
  ds_read_b64_tr_b16 v[108:109], v11 offset:27840
  ds_read_b64_tr_b16 v[110:111], v11 offset:28992
  ds_read_b64_tr_b16 v[112:113], v11 offset:224
  ds_read_b64_tr_b16 v[114:115], v11 offset:1376
  ds_read_b64_tr_b16 v[116:117], v11 offset:9440
  ds_read_b64_tr_b16 v[118:119], v11 offset:10592
  ds_read_b64_tr_b16 v[120:121], v11 offset:18656
  ds_read_b64_tr_b16 v[122:123], v11 offset:19808
  ds_read_b64_tr_b16 v[124:125], v11 offset:27872
  ds_read_b64_tr_b16 v[126:127], v11 offset:29024
  v_mul_f32 v128, s42, v128
  v_mul_f32 v129, s42, v129
  v_mul_f32 v130, s42, v130
  v_mul_f32 v131, s42, v131
  v_mul_f32 v132, s42, v132
  v_mul_f32 v133, s42, v133
  v_mul_f32 v134, s42, v134
  v_mul_f32 v135, s42, v135
  v_mul_f32 v136, s42, v136
  v_mul_f32 v137, s42, v137
  v_mul_f32 v138, s42, v138
  v_mul_f32 v139, s42, v139
  v_mul_f32 v140, s42, v140
  v_mul_f32 v141, s42, v141
  v_mul_f32 v142, s42, v142
  v_mul_f32 v143, s42, v143
  v_mul_f32 v144, s42, v144
  v_mul_f32 v145, s42, v145
  v_mul_f32 v146, s42, v146
  v_mul_f32 v147, s42, v147
  v_mul_f32 v148, s42, v148
  v_mul_f32 v149, s42, v149
  v_mul_f32 v150, s42, v150
  v_mul_f32 v151, s42, v151
  v_mul_f32 v152, s42, v152
  v_mul_f32 v153, s42, v153
  v_mul_f32 v154, s42, v154
  v_mul_f32 v155, s42, v155
  v_mul_f32 v156, s42, v156
  v_mul_f32 v157, s42, v157
  v_mul_f32 v158, s42, v158
  v_mul_f32 v159, s42, v159
  v_cvt_pk_bf16_f32 v160, v128, v132
  v_cvt_pk_bf16_f32 v161, v136, v140
  v_cvt_pk_bf16_f32 v162, v129, v133
  v_cvt_pk_bf16_f32 v163, v137, v141
  v_cvt_pk_bf16_f32 v164, v130, v134
  v_cvt_pk_bf16_f32 v165, v138, v142
  v_cvt_pk_bf16_f32 v166, v131, v135
  v_cvt_pk_bf16_f32 v167, v139, v143
  v_cvt_pk_bf16_f32 v168, v144, v148
  v_cvt_pk_bf16_f32 v169, v152, v156
  v_cvt_pk_bf16_f32 v170, v145, v149
  v_cvt_pk_bf16_f32 v171, v153, v157
  v_cvt_pk_bf16_f32 v172, v146, v150
  v_cvt_pk_bf16_f32 v173, v154, v158
  v_cvt_pk_bf16_f32 v174, v147, v151
  v_cvt_pk_bf16_f32 v175, v155, v159
  buffer_store_dwordx2 v[160:161], v14, s[20:23], s44 offen offset:128 sc0 sc1
  buffer_store_dwordx2 v[162:163], v14, s[20:23], s44 offen offset:384 sc0 sc1
  buffer_store_dwordx2 v[164:165], v14, s[20:23], s44 offen offset:640 sc0 sc1
  buffer_store_dwordx2 v[166:167], v14, s[20:23], s44 offen offset:896 sc0 sc1
  buffer_store_dwordx2 v[168:169], v15, s[20:23], s44 offen offset:128 sc0 sc1
  buffer_store_dwordx2 v[170:171], v15, s[20:23], s44 offen offset:384 sc0 sc1
  buffer_store_dwordx2 v[172:173], v15, s[20:23], s44 offen offset:640 sc0 sc1
  buffer_store_dwordx2 v[174:175], v15, s[20:23], s44 offen offset:896 sc0 sc1
  s_waitcnt lgkmcnt(0)
  v_mfma_f32_16x16x32_bf16 v[128:131], v[32:35], v[64:67], 0
  v_mfma_f32_16x16x32_bf16 v[132:135], v[32:35], v[80:83], 0
  v_mfma_f32_16x16x32_bf16 v[136:139], v[32:35], v[96:99], 0
  v_mfma_f32_16x16x32_bf16 v[140:143], v[32:35], v[112:115], 0
  v_mfma_f32_16x16x32_bf16 v[144:147], v[48:51], v[64:67], 0
  v_mfma_f32_16x16x32_bf16 v[148:151], v[48:51], v[80:83], 0
  v_mfma_f32_16x16x32_bf16 v[152:155], v[48:51], v[96:99], 0
  v_mfma_f32_16x16x32_bf16 v[156:159], v[48:51], v[112:115], 0
  v_mfma_f32_16x16x32_bf16 v[128:131], v[36:39], v[68:71], v[128:131]
  v_mfma_f32_16x16x32_bf16 v[132:135], v[36:39], v[84:87], v[132:135]
  v_mfma_f32_16x16x32_bf16 v[136:139], v[36:39], v[100:103], v[136:139]
  v_mfma_f32_16x16x32_bf16 v[140:143], v[36:39], v[116:119], v[140:143]
  v_mfma_f32_16x16x32_bf16 v[144:147], v[52:55], v[68:71], v[144:147]
  v_mfma_f32_16x16x32_bf16 v[148:151], v[52:55], v[84:87], v[148:151]
  v_mfma_f32_16x16x32_bf16 v[152:155], v[52:55], v[100:103], v[152:155]
  v_mfma_f32_16x16x32_bf16 v[156:159], v[52:55], v[116:119], v[156:159]
  v_mfma_f32_16x16x32_bf16 v[128:131], v[40:43], v[72:75], v[128:131]
  v_mfma_f32_16x16x32_bf16 v[132:135], v[40:43], v[88:91], v[132:135]
  v_mfma_f32_16x16x32_bf16 v[136:139], v[40:43], v[104:107], v[136:139]
  v_mfma_f32_16x16x32_bf16 v[140:143], v[40:43], v[120:123], v[140:143]
  v_mfma_f32_16x16x32_bf16 v[144:147], v[56:59], v[72:75], v[144:147]
  v_mfma_f32_16x16x32_bf16 v[148:151], v[56:59], v[88:91], v[148:151]
  v_mfma_f32_16x16x32_bf16 v[152:155], v[56:59], v[104:107], v[152:155]
  v_mfma_f32_16x16x32_bf16 v[156:159], v[56:59], v[120:123], v[156:159]
  v_mfma_f32_16x16x32_bf16 v[128:131], v[44:47], v[76:79], v[128:131]
  v_mfma_f32_16x16x32_bf16 v[132:135], v[44:47], v[92:95], v[132:135]
  v_mfma_f32_16x16x32_bf16 v[136:139], v[44:47], v[108:111], v[136:139]
  v_mfma_f32_16x16x32_bf16 v[140:143], v[44:47], v[124:127], v[140:143]
  v_mfma_f32_16x16x32_bf16 v[144:147], v[60:63], v[76:79], v[144:147]
  v_mfma_f32_16x16x32_bf16 v[148:151], v[60:63], v[92:95], v[148:151]
  v_mfma_f32_16x16x32_bf16 v[152:155], v[60:63], v[108:111], v[152:155]
  v_mfma_f32_16x16x32_bf16 v[156:159], v[60:63], v[124:127], v[156:159]
  s_nop 7
  s_nop 1
  v_cvt_pk_bf16_f32 v176, v128, v132
  v_cvt_pk_bf16_f32 v177, v136, v140
  v_cvt_pk_bf16_f32 v178, v129, v133
  v_cvt_pk_bf16_f32 v179, v137, v141
  v_cvt_pk_bf16_f32 v180, v130, v134
  v_cvt_pk_bf16_f32 v181, v138, v142
  v_cvt_pk_bf16_f32 v182, v131, v135
  v_cvt_pk_bf16_f32 v183, v139, v143
  v_cvt_pk_bf16_f32 v184, v144, v148
  v_cvt_pk_bf16_f32 v185, v152, v156
  v_cvt_pk_bf16_f32 v186, v145, v149
  v_cvt_pk_bf16_f32 v187, v153, v157
  v_cvt_pk_bf16_f32 v188, v146, v150
  v_cvt_pk_bf16_f32 v189, v154, v158
  v_cvt_pk_bf16_f32 v190, v147, v151
  v_cvt_pk_bf16_f32 v191, v155, v159
  buffer_store_dwordx2 v[176:177], v14, s[20:23], s45 offen offset:128 sc0 sc1
  buffer_store_dwordx2 v[178:179], v14, s[20:23], s45 offen offset:384 sc0 sc1
  buffer_store_dwordx2 v[180:181], v14, s[20:23], s45 offen offset:640 sc0 sc1
  buffer_store_dwordx2 v[182:183], v14, s[20:23], s45 offen offset:896 sc0 sc1
  buffer_store_dwordx2 v[184:185], v15, s[20:23], s45 offen offset:128 sc0 sc1
  buffer_store_dwordx2 v[186:187], v15, s[20:23], s45 offen offset:384 sc0 sc1
  buffer_store_dwordx2 v[188:189], v15, s[20:23], s45 offen offset:640 sc0 sc1
  buffer_store_dwordx2 v[190:191], v15, s[20:23], s45 offen offset:896 sc0 sc1
  s_endpgm
K0_GEMM1:
  s_mov_b32 s45, 0xffff0000
  s_mov_b32 s46, 0x80000000
  v_lshlrev_b32 v14, 9, v12
  v_lshl_add_u32 v14, v2, 4, v14
  v_add_u32 v15, 8192, v14
  s_waitcnt lgkmcnt(0)
  v_mfma_f32_16x16x32_bf16 v[128:131], v[32:35], v[64:67], 0
  v_mfma_f32_16x16x32_bf16 v[132:135], v[32:35], v[80:83], 0
  v_mfma_f32_16x16x32_bf16 v[136:139], v[32:35], v[96:99], 0
  v_mfma_f32_16x16x32_bf16 v[140:143], v[32:35], v[112:115], 0
  v_mfma_f32_16x16x32_bf16 v[144:147], v[48:51], v[64:67], 0
  v_mfma_f32_16x16x32_bf16 v[148:151], v[48:51], v[80:83], 0
  v_mfma_f32_16x16x32_bf16 v[152:155], v[48:51], v[96:99], 0
  v_mfma_f32_16x16x32_bf16 v[156:159], v[48:51], v[112:115], 0
  v_mfma_f32_16x16x32_bf16 v[128:131], v[36:39], v[68:71], v[128:131]
  v_mfma_f32_16x16x32_bf16 v[132:135], v[36:39], v[84:87], v[132:135]
  v_mfma_f32_16x16x32_bf16 v[136:139], v[36:39], v[100:103], v[136:139]
  v_mfma_f32_16x16x32_bf16 v[140:143], v[36:39], v[116:119], v[140:143]
  v_mfma_f32_16x16x32_bf16 v[144:147], v[52:55], v[68:71], v[144:147]
  v_mfma_f32_16x16x32_bf16 v[148:151], v[52:55], v[84:87], v[148:151]
  v_mfma_f32_16x16x32_bf16 v[152:155], v[52:55], v[100:103], v[152:155]
  v_mfma_f32_16x16x32_bf16 v[156:159], v[52:55], v[116:119], v[156:159]
  v_mfma_f32_16x16x32_bf16 v[128:131], v[40:43], v[72:75], v[128:131]
  v_mfma_f32_16x16x32_bf16 v[132:135], v[40:43], v[88:91], v[132:135]
  v_mfma_f32_16x16x32_bf16 v[136:139], v[40:43], v[104:107], v[136:139]
  v_mfma_f32_16x16x32_bf16 v[140:143], v[40:43], v[120:123], v[140:143]
  v_mfma_f32_16x16x32_bf16 v[144:147], v[56:59], v[72:75], v[144:147]
  v_mfma_f32_16x16x32_bf16 v[148:151], v[56:59], v[88:91], v[148:151]
  v_mfma_f32_16x16x32_bf16 v[152:155], v[56:59], v[104:107], v[152:155]
  v_mfma_f32_16x16x32_bf16 v[156:159], v[56:59], v[120:123], v[156:159]
  v_mfma_f32_16x16x32_bf16 v[128:131], v[44:47], v[76:79], v[128:131]
  v_mfma_f32_16x16x32_bf16 v[132:135], v[44:47], v[92:95], v[132:135]
  v_mfma_f32_16x16x32_bf16 v[136:139], v[44:47], v[108:111], v[136:139]
  v_mfma_f32_16x16x32_bf16 v[140:143], v[44:47], v[124:127], v[140:143]
  v_mfma_f32_16x16x32_bf16 v[144:147], v[60:63], v[76:79], v[144:147]
  v_mfma_f32_16x16x32_bf16 v[148:151], v[60:63], v[92:95], v[148:151]
  v_mfma_f32_16x16x32_bf16 v[152:155], v[60:63], v[108:111], v[152:155]
  v_mfma_f32_16x16x32_bf16 v[156:159], v[60:63], v[124:127], v[156:159]
  s_nop 7
  s_nop 1
  ds_read_b64_tr_b16 v[64:65], v11 offset:0
  ds_read_b64_tr_b16 v[66:67], v11 offset:1152
  ds_read_b64_tr_b16 v[68:69], v11 offset:9216
  ds_read_b64_tr_b16 v[70:71], v11 offset:10368
  ds_read_b64_tr_b16 v[72:73], v11 offset:18432
  ds_read_b64_tr_b16 v[74:75], v11 offset:19584
  ds_read_b64_tr_b16 v[76:77], v11 offset:27648
  ds_read_b64_tr_b16 v[78:79], v11 offset:28800
  ds_read_b64_tr_b16 v[80:81], v11 offset:32
  ds_read_b64_tr_b16 v[82:83], v11 offset:1184
  ds_read_b64_tr_b16 v[84:85], v11 offset:9248
  ds_read_b64_tr_b16 v[86:87], v11 offset:10400
  ds_read_b64_tr_b16 v[88:89], v11 offset:18464
  ds_read_b64_tr_b16 v[90:91], v11 offset:19616
  ds_read_b64_tr_b16 v[92:93], v11 offset:27680
  ds_read_b64_tr_b16 v[94:95], v11 offset:28832
  ds_read_b64_tr_b16 v[96:97], v11 offset:64
  ds_read_b64_tr_b16 v[98:99], v11 offset:1216
  ds_read_b64_tr_b16 v[100:101], v11 offset:9280
  ds_read_b64_tr_b16 v[102:103], v11 offset:10432
  ds_read_b64_tr_b16 v[104:105], v11 offset:18496
  ds_read_b64_tr_b16 v[106:107], v11 offset:19648
  ds_read_b64_tr_b16 v[108:109], v11 offset:27712
  ds_read_b64_tr_b16 v[110:111], v11 offset:28864
  ds_read_b64_tr_b16 v[112:113], v11 offset:96
  ds_read_b64_tr_b16 v[114:115], v11 offset:1248
  ds_read_b64_tr_b16 v[116:117], v11 offset:9312
  ds_read_b64_tr_b16 v[118:119], v11 offset:10464
  ds_read_b64_tr_b16 v[120:121], v11 offset:18528
  ds_read_b64_tr_b16 v[122:123], v11 offset:19680
  ds_read_b64_tr_b16 v[124:125], v11 offset:27744
  ds_read_b64_tr_b16 v[126:127], v11 offset:28896
  v_mul_f32 v128, s42, v128
  v_mul_f32 v129, s42, v129
  v_mul_f32 v130, s42, v130
  v_mul_f32 v131, s42, v131
  v_mul_f32 v132, s42, v132
  v_mul_f32 v133, s42, v133
  v_mul_f32 v134, s42, v134
  v_mul_f32 v135, s42, v135
  v_mul_f32 v136, s42, v136
  v_mul_f32 v137, s42, v137
  v_mul_f32 v138, s42, v138
  v_mul_f32 v139, s42, v139
  v_mul_f32 v140, s42, v140
  v_mul_f32 v141, s42, v141
  v_mul_f32 v142, s42, v142
  v_mul_f32 v143, s42, v143
  v_mul_f32 v144, s42, v144
  v_mul_f32 v145, s42, v145
  v_mul_f32 v146, s42, v146
  v_mul_f32 v147, s42, v147
  v_mul_f32 v148, s42, v148
  v_mul_f32 v149, s42, v149
  v_mul_f32 v150, s42, v150
  v_mul_f32 v151, s42, v151
  v_mul_f32 v152, s42, v152
  v_mul_f32 v153, s42, v153
  v_mul_f32 v154, s42, v154
  v_mul_f32 v155, s42, v155
  v_mul_f32 v156, s42, v156
  v_mul_f32 v157, s42, v157
  v_mul_f32 v158, s42, v158
  v_mul_f32 v159, s42, v159
  v_cvt_pk_bf16_f32 v160, v128, v132
  v_cvt_pk_bf16_f32 v161, v136, v140
  v_cvt_pk_bf16_f32 v164, v129, v133
  v_cvt_pk_bf16_f32 v165, v137, v141
  v_cvt_pk_bf16_f32 v168, v130, v134
  v_cvt_pk_bf16_f32 v169, v138, v142
  v_cvt_pk_bf16_f32 v172, v131, v135
  v_cvt_pk_bf16_f32 v173, v139, v143
  v_cvt_pk_bf16_f32 v176, v144, v148
  v_cvt_pk_bf16_f32 v177, v152, v156
  v_cvt_pk_bf16_f32 v180, v145, v149
  v_cvt_pk_bf16_f32 v181, v153, v157
  v_cvt_pk_bf16_f32 v184, v146, v150
  v_cvt_pk_bf16_f32 v185, v154, v158
  v_cvt_pk_bf16_f32 v188, v147, v151
  v_cvt_pk_bf16_f32 v189, v155, v159
  s_waitcnt lgkmcnt(0)
  v_mfma_f32_16x16x32_bf16 v[128:131], v[32:35], v[64:67], 0
  v_mfma_f32_16x16x32_bf16 v[132:135], v[32:35], v[80:83], 0
  v_mfma_f32_16x16x32_bf16 v[136:139], v[32:35], v[96:99], 0
  v_mfma_f32_16x16x32_bf16 v[140:143], v[32:35], v[112:115], 0
  v_mfma_f32_16x16x32_bf16 v[144:147], v[48:51], v[64:67], 0
  v_mfma_f32_16x16x32_bf16 v[148:151], v[48:51], v[80:83], 0
  v_mfma_f32_16x16x32_bf16 v[152:155], v[48:51], v[96:99], 0
  v_mfma_f32_16x16x32_bf16 v[156:159], v[48:51], v[112:115], 0
  v_mfma_f32_16x16x32_bf16 v[128:131], v[36:39], v[68:71], v[128:131]
  v_mfma_f32_16x16x32_bf16 v[132:135], v[36:39], v[84:87], v[132:135]
  v_mfma_f32_16x16x32_bf16 v[136:139], v[36:39], v[100:103], v[136:139]
  v_mfma_f32_16x16x32_bf16 v[140:143], v[36:39], v[116:119], v[140:143]
  v_mfma_f32_16x16x32_bf16 v[144:147], v[52:55], v[68:71], v[144:147]
  v_mfma_f32_16x16x32_bf16 v[148:151], v[52:55], v[84:87], v[148:151]
  v_mfma_f32_16x16x32_bf16 v[152:155], v[52:55], v[100:103], v[152:155]
  v_mfma_f32_16x16x32_bf16 v[156:159], v[52:55], v[116:119], v[156:159]
  v_mfma_f32_16x16x32_bf16 v[128:131], v[40:43], v[72:75], v[128:131]
  v_mfma_f32_16x16x32_bf16 v[132:135], v[40:43], v[88:91], v[132:135]
  v_mfma_f32_16x16x32_bf16 v[136:139], v[40:43], v[104:107], v[136:139]
  v_mfma_f32_16x16x32_bf16 v[140:143], v[40:43], v[120:123], v[140:143]
  v_mfma_f32_16x16x32_bf16 v[144:147], v[56:59], v[72:75], v[144:147]
  v_mfma_f32_16x16x32_bf16 v[148:151], v[56:59], v[88:91], v[148:151]
  v_mfma_f32_16x16x32_bf16 v[152:155], v[56:59], v[104:107], v[152:155]
  v_mfma_f32_16x16x32_bf16 v[156:159], v[56:59], v[120:123], v[156:159]
  v_mfma_f32_16x16x32_bf16 v[128:131], v[44:47], v[76:79], v[128:131]
  v_mfma_f32_16x16x32_bf16 v[132:135], v[44:47], v[92:95], v[132:135]
  v_mfma_f32_16x16x32_bf16 v[136:139], v[44:47], v[108:111], v[136:139]
  v_mfma_f32_16x16x32_bf16 v[140:143], v[44:47], v[124:127], v[140:143]
  v_mfma_f32_16x16x32_bf16 v[144:147], v[60:63], v[76:79], v[144:147]
  v_mfma_f32_16x16x32_bf16 v[148:151], v[60:63], v[92:95], v[148:151]
  v_mfma_f32_16x16x32_bf16 v[152:155], v[60:63], v[108:111], v[152:155]
  v_mfma_f32_16x16x32_bf16 v[156:159], v[60:63], v[124:127], v[156:159]
  s_nop 7
  s_nop 1
  ds_read_b64_tr_b16 v[64:65], v10 offset:128
  ds_read_b64_tr_b16 v[66:67], v10 offset:1280
  ds_read_b64_tr_b16 v[68:69], v10 offset:9344
  ds_read_b64_tr_b16 v[70:71], v10 offset:10496
  ds_read_b64_tr_b16 v[72:73], v10 offset:18560
  ds_read_b64_tr_b16 v[74:75], v10 offset:19712
  ds_read_b64_tr_b16 v[76:77], v10 offset:27776
  ds_read_b64_tr_b16 v[78:79], v10 offset:28928
  ds_read_b64_tr_b16 v[80:81], v10 offset:160
  ds_read_b64_tr_b16 v[82:83], v10 offset:1312
  ds_read_b64_tr_b16 v[84:85], v10 offset:9376
  ds_read_b64_tr_b16 v[86:87], v10 offset:10528
  ds_read_b64_tr_b16 v[88:89], v10 offset:18592
  ds_read_b64_tr_b16 v[90:91], v10 offset:19744
  ds_read_b64_tr_b16 v[92:93], v10 offset:27808
  ds_read_b64_tr_b16 v[94:95], v10 offset:28960
  ds_read_b64_tr_b16 v[96:97], v10 offset:192
  ds_read_b64_tr_b16 v[98:99], v10 offset:1344
  ds_read_b64_tr_b16 v[100:101], v10 offset:9408
  ds_read_b64_tr_b16 v[102:103], v10 offset:10560
  ds_read_b64_tr_b16 v[104:105], v10 offset:18624
  ds_read_b64_tr_b16 v[106:107], v10 offset:19776
  ds_read_b64_tr_b16 v[108:109], v10 offset:27840
  ds_read_b64_tr_b16 v[110:111], v10 offset:28992
  ds_read_b64_tr_b16 v[112:113], v10 offset:224
  ds_read_b64_tr_b16 v[114:115], v10 offset:1376
  ds_read_b64_tr_b16 v[116:117], v10 offset:9440
  ds_read_b64_tr_b16 v[118:119], v10 offset:10592
  ds_read_b64_tr_b16 v[120:121], v10 offset:18656
  ds_read_b64_tr_b16 v[122:123], v10 offset:19808
  ds_read_b64_tr_b16 v[124:125], v10 offset:27872
  ds_read_b64_tr_b16 v[126:127], v10 offset:29024
  v_cvt_pk_bf16_f32 v16, v128, v128
  v_and_b32 v16, 0xffff, v16
  v_and_b32 v17, 0x7fffffff, v132
  v_add_u32 v17, 0x8000, v17
  v_max_u32 v17, v17, v16
  v_sub_u32 v17, v17, v16
  v_and_or_b32 v17, v17, s45, v16
  v_bfi_b32 v162, s46, v132, v17
  v_cvt_pk_bf16_f32 v16, v136, v136
  v_and_b32 v16, 0xffff, v16
  v_and_b32 v17, 0x7fffffff, v140
  v_add_u32 v17, 0x8000, v17
  v_max_u32 v17, v17, v16
  v_sub_u32 v17, v17, v16
  v_and_or_b32 v17, v17, s45, v16
  v_bfi_b32 v163, s46, v140, v17
  v_cvt_pk_bf16_f32 v16, v129, v129
  v_and_b32 v16, 0xffff, v16
  v_and_b32 v17, 0x7fffffff, v133
  v_add_u32 v17, 0x8000, v17
  v_max_u32 v17, v17, v16
  v_sub_u32 v17, v17, v16
  v_and_or_b32 v17, v17, s45, v16
  v_bfi_b32 v166, s46, v133, v17
  v_cvt_pk_bf16_f32 v16, v137, v137
  v_and_b32 v16, 0xffff, v16
  v_and_b32 v17, 0x7fffffff, v141
  v_add_u32 v17, 0x8000, v17
  v_max_u32 v17, v17, v16
  v_sub_u32 v17, v17, v16
  v_and_or_b32 v17, v17, s45, v16
  v_bfi_b32 v167, s46, v141, v17
  v_cvt_pk_bf16_f32 v16, v130, v130
  v_and_b32 v16, 0xffff, v16
  v_and_b32 v17, 0x7fffffff, v134
  v_add_u32 v17, 0x8000, v17
  v_max_u32 v17, v17, v16
  v_sub_u32 v17, v17, v16
  v_and_or_b32 v17, v17, s45, v16
  v_bfi_b32 v170, s46, v134, v17
  v_cvt_pk_bf16_f32 v16, v138, v138
  v_and_b32 v16, 0xffff, v16
  v_and_b32 v17, 0x7fffffff, v142
  v_add_u32 v17, 0x8000, v17
  v_max_u32 v17, v17, v16
  v_sub_u32 v17, v17, v16
  v_and_or_b32 v17, v17, s45, v16
  v_bfi_b32 v171, s46, v142, v17
  v_cvt_pk_bf16_f32 v16, v131, v131
  v_and_b32 v16, 0xffff, v16
  v_and_b32 v17, 0x7fffffff, v135
  v_add_u32 v17, 0x8000, v17
  v_max_u32 v17, v17, v16
  v_sub_u32 v17, v17, v16
  v_and_or_b32 v17, v17, s45, v16
  v_bfi_b32 v174, s46, v135, v17
  v_cvt_pk_bf16_f32 v16, v139, v139
  v_and_b32 v16, 0xffff, v16
  v_and_b32 v17, 0x7fffffff, v143
  v_add_u32 v17, 0x8000, v17
  v_max_u32 v17, v17, v16
  v_sub_u32 v17, v17, v16
  v_and_or_b32 v17, v17, s45, v16
  v_bfi_b32 v175, s46, v143, v17
  v_cvt_pk_bf16_f32 v16, v144, v144
  v_and_b32 v16, 0xffff, v16
  v_and_b32 v17, 0x7fffffff, v148
  v_add_u32 v17, 0x8000, v17
  v_max_u32 v17, v17, v16
  v_sub_u32 v17, v17, v16
  v_and_or_b32 v17, v17, s45, v16
  v_bfi_b32 v178, s46, v148, v17
  v_cvt_pk_bf16_f32 v16, v152, v152
  v_and_b32 v16, 0xffff, v16
  v_and_b32 v17, 0x7fffffff, v156
  v_add_u32 v17, 0x8000, v17
  v_max_u32 v17, v17, v16
  v_sub_u32 v17, v17, v16
  v_and_or_b32 v17, v17, s45, v16
  v_bfi_b32 v179, s46, v156, v17
  v_cvt_pk_bf16_f32 v16, v145, v145
  v_and_b32 v16, 0xffff, v16
  v_and_b32 v17, 0x7fffffff, v149
  v_add_u32 v17, 0x8000, v17
  v_max_u32 v17, v17, v16
  v_sub_u32 v17, v17, v16
  v_and_or_b32 v17, v17, s45, v16
  v_bfi_b32 v182, s46, v149, v17
  v_cvt_pk_bf16_f32 v16, v153, v153
  v_and_b32 v16, 0xffff, v16
  v_and_b32 v17, 0x7fffffff, v157
  v_add_u32 v17, 0x8000, v17
  v_max_u32 v17, v17, v16
  v_sub_u32 v17, v17, v16
  v_and_or_b32 v17, v17, s45, v16
  v_bfi_b32 v183, s46, v157, v17
  v_cvt_pk_bf16_f32 v16, v146, v146
  v_and_b32 v16, 0xffff, v16
  v_and_b32 v17, 0x7fffffff, v150
  v_add_u32 v17, 0x8000, v17
  v_max_u32 v17, v17, v16
  v_sub_u32 v17, v17, v16
  v_and_or_b32 v17, v17, s45, v16
  v_bfi_b32 v186, s46, v150, v17
  v_cvt_pk_bf16_f32 v16, v154, v154
  v_and_b32 v16, 0xffff, v16
  v_and_b32 v17, 0x7fffffff, v158
  v_add_u32 v17, 0x8000, v17
  v_max_u32 v17, v17, v16
  v_sub_u32 v17, v17, v16
  v_and_or_b32 v17, v17, s45, v16
  v_bfi_b32 v187, s46, v158, v17
  v_cvt_pk_bf16_f32 v16, v147, v147
  v_and_b32 v16, 0xffff, v16
  v_and_b32 v17, 0x7fffffff, v151
  v_add_u32 v17, 0x8000, v17
  v_max_u32 v17, v17, v16
  v_sub_u32 v17, v17, v16
  v_and_or_b32 v17, v17, s45, v16
  v_bfi_b32 v190, s46, v151, v17
  v_cvt_pk_bf16_f32 v16, v155, v155
  v_and_b32 v16, 0xffff, v16
  v_and_b32 v17, 0x7fffffff, v159
  v_add_u32 v17, 0x8000, v17
  v_max_u32 v17, v17, v16
  v_sub_u32 v17, v17, v16
  v_and_or_b32 v17, v17, s45, v16
  v_bfi_b32 v191, s46, v159, v17
  buffer_store_dwordx4 v[160:163], v14, s[20:23], 0 offen offset:0 sc0 sc1
  buffer_store_dwordx4 v[164:167], v14, s[20:23], 0 offen offset:512 sc0 sc1
  buffer_store_dwordx4 v[168:171], v14, s[20:23], 0 offen offset:1024 sc0 sc1
  buffer_store_dwordx4 v[172:175], v14, s[20:23], 0 offen offset:1536 sc0 sc1
  buffer_store_dwordx4 v[176:179], v15, s[20:23], 0 offen offset:0 sc0 sc1
  buffer_store_dwordx4 v[180:183], v15, s[20:23], 0 offen offset:512 sc0 sc1
  buffer_store_dwordx4 v[184:187], v15, s[20:23], 0 offen offset:1024 sc0 sc1
  buffer_store_dwordx4 v[188:191], v15, s[20:23], 0 offen offset:1536 sc0 sc1
  s_nop 1
  s_waitcnt lgkmcnt(0)
  v_mfma_f32_16x16x32_bf16 v[128:131], v[32:35], v[64:67], 0
  v_mfma_f32_16x16x32_bf16 v[132:135], v[32:35], v[80:83], 0
  v_mfma_f32_16x16x32_bf16 v[136:139], v[32:35], v[96:99], 0
  v_mfma_f32_16x16x32_bf16 v[140:143], v[32:35], v[112:115], 0
  v_mfma_f32_16x16x32_bf16 v[144:147], v[48:51], v[64:67], 0
  v_mfma_f32_16x16x32_bf16 v[148:151], v[48:51], v[80:83], 0
  v_mfma_f32_16x16x32_bf16 v[152:155], v[48:51], v[96:99], 0
  v_mfma_f32_16x16x32_bf16 v[156:159], v[48:51], v[112:115], 0
  v_mfma_f32_16x16x32_bf16 v[128:131], v[36:39], v[68:71], v[128:131]
  v_mfma_f32_16x16x32_bf16 v[132:135], v[36:39], v[84:87], v[132:135]
  v_mfma_f32_16x16x32_bf16 v[136:139], v[36:39], v[100:103], v[136:139]
  v_mfma_f32_16x16x32_bf16 v[140:143], v[36:39], v[116:119], v[140:143]
  v_mfma_f32_16x16x32_bf16 v[144:147], v[52:55], v[68:71], v[144:147]
  v_mfma_f32_16x16x32_bf16 v[148:151], v[52:55], v[84:87], v[148:151]
  v_mfma_f32_16x16x32_bf16 v[152:155], v[52:55], v[100:103], v[152:155]
  v_mfma_f32_16x16x32_bf16 v[156:159], v[52:55], v[116:119], v[156:159]
  v_mfma_f32_16x16x32_bf16 v[128:131], v[40:43], v[72:75], v[128:131]
  v_mfma_f32_16x16x32_bf16 v[132:135], v[40:43], v[88:91], v[132:135]
  v_mfma_f32_16x16x32_bf16 v[136:139], v[40:43], v[104:107], v[136:139]
  v_mfma_f32_16x16x32_bf16 v[140:143], v[40:43], v[120:123], v[140:143]
  v_mfma_f32_16x16x32_bf16 v[144:147], v[56:59], v[72:75], v[144:147]
  v_mfma_f32_16x16x32_bf16 v[148:151], v[56:59], v[88:91], v[148:151]
  v_mfma_f32_16x16x32_bf16 v[152:155], v[56:59], v[104:107], v[152:155]
  v_mfma_f32_16x16x32_bf16 v[156:159], v[56:59], v[120:123], v[156:159]
  v_mfma_f32_16x16x32_bf16 v[128:131], v[44:47], v[76:79], v[128:131]
  v_mfma_f32_16x16x32_bf16 v[132:135], v[44:47], v[92:95], v[132:135]
  v_mfma_f32_16x16x32_bf16 v[136:139], v[44:47], v[108:111], v[136:139]
  v_mfma_f32_16x16x32_bf16 v[140:143], v[44:47], v[124:127], v[140:143]
  v_mfma_f32_16x16x32_bf16 v[144:147], v[60:63], v[76:79], v[144:147]
  v_mfma_f32_16x16x32_bf16 v[148:151], v[60:63], v[92:95], v[148:151]
  v_mfma_f32_16x16x32_bf16 v[152:155], v[60:63], v[108:111], v[152:155]
  v_mfma_f32_16x16x32_bf16 v[156:159], v[60:63], v[124:127], v[156:159]
  s_nop 7
  s_nop 1
  ds_read_b64_tr_b16 v[64:65], v11 offset:128
  ds_read_b64_tr_b16 v[66:67], v11 offset:1280
  ds_read_b64_tr_b16 v[68:69], v11 offset:9344
  ds_read_b64_tr_b16 v[70:71], v11 offset:10496
  ds_read_b64_tr_b16 v[72:73], v11 offset:18560
  ds_read_b64_tr_b16 v[74:75], v11 offset:19712
  ds_read_b64_tr_b16 v[76:77], v11 offset:27776
  ds_read_b64_tr_b16 v[78:79], v11 offset:28928
  ds_read_b64_tr_b16 v[80:81], v11 offset:160
  ds_read_b64_tr_b16 v[82:83], v11 offset:1312
  ds_read_b64_tr_b16 v[84:85], v11 offset:9376
  ds_read_b64_tr_b16 v[86:87], v11 offset:10528
  ds_read_b64_tr_b16 v[88:89], v11 offset:18592
  ds_read_b64_tr_b16 v[90:91], v11 offset:19744
  ds_read_b64_tr_b16 v[92:93], v11 offset:27808
  ds_read_b64_tr_b16 v[94:95], v11 offset:28960
  ds_read_b64_tr_b16 v[96:97], v11 offset:192
  ds_read_b64_tr_b16 v[98:99], v11 offset:1344
  ds_read_b64_tr_b16 v[100:101], v11 offset:9408
  ds_read_b64_tr_b16 v[102:103], v11 offset:10560
  ds_read_b64_tr_b16 v[104:105], v11 offset:18624
  ds_read_b64_tr_b16 v[106:107], v11 offset:19776
  ds_read_b64_tr_b16 v[108:109], v11 offset:27840
  ds_read_b64_tr_b16 v[110:111], v11 offset:28992
  ds_read_b64_tr_b16 v[112:113], v11 offset:224
  ds_read_b64_tr_b16 v[114:115], v11 offset:1376
  ds_read_b64_tr_b16 v[116:117], v11 offset:9440
  ds_read_b64_tr_b16 v[118:119], v11 offset:10592
  ds_read_b64_tr_b16 v[120:121], v11 offset:18656
  ds_read_b64_tr_b16 v[122:123], v11 offset:19808
  ds_read_b64_tr_b16 v[124:125], v11 offset:27872
  ds_read_b64_tr_b16 v[126:127], v11 offset:29024
  v_mul_f32 v128, s42, v128
  v_mul_f32 v129, s42, v129
  v_mul_f32 v130, s42, v130
  v_mul_f32 v131, s42, v131
  v_mul_f32 v132, s42, v132
  v_mul_f32 v133, s42, v133
  v_mul_f32 v134, s42, v134
  v_mul_f32 v135, s42, v135
  v_mul_f32 v136, s42, v136
  v_mul_f32 v137, s42, v137
  v_mul_f32 v138, s42, v138
  v_mul_f32 v139, s42, v139
  v_mul_f32 v140, s42, v140
  v_mul_f32 v141, s42, v141
  v_mul_f32 v142, s42, v142
  v_mul_f32 v143, s42, v143
  v_mul_f32 v144, s42, v144
  v_mul_f32 v145, s42, v145
  v_mul_f32 v146, s42, v146
  v_mul_f32 v147, s42, v147
  v_mul_f32 v148, s42, v148
  v_mul_f32 v149, s42, v149
  v_mul_f32 v150, s42, v150
  v_mul_f32 v151, s42, v151
  v_mul_f32 v152, s42, v152
  v_mul_f32 v153, s42, v153
  v_mul_f32 v154, s42, v154
  v_mul_f32 v155, s42, v155
  v_mul_f32 v156, s42, v156
  v_mul_f32 v157, s42, v157
  v_mul_f32 v158, s42, v158
  v_mul_f32 v159, s42, v159
  v_cvt_pk_bf16_f32 v160, v128, v132
  v_cvt_pk_bf16_f32 v161, v136, v140
  v_cvt_pk_bf16_f32 v164, v129, v133
  v_cvt_pk_bf16_f32 v165, v137, v141
  v_cvt_pk_bf16_f32 v168, v130, v134
  v_cvt_pk_bf16_f32 v169, v138, v142
  v_cvt_pk_bf16_f32 v172, v131, v135
  v_cvt_pk_bf16_f32 v173, v139, v143
  v_cvt_pk_bf16_f32 v176, v144, v148
  v_cvt_pk_bf16_f32 v177, v152, v156
  v_cvt_pk_bf16_f32 v180, v145, v149
  v_cvt_pk_bf16_f32 v181, v153, v157
  v_cvt_pk_bf16_f32 v184, v146, v150
  v_cvt_pk_bf16_f32 v185, v154, v158
  v_cvt_pk_bf16_f32 v188, v147, v151
  v_cvt_pk_bf16_f32 v189, v155, v159
  s_waitcnt lgkmcnt(0)
  v_mfma_f32_16x16x32_bf16 v[128:131], v[32:35], v[64:67], 0
  v_mfma_f32_16x16x32_bf16 v[132:135], v[32:35], v[80:83], 0
  v_mfma_f32_16x16x32_bf16 v[136:139], v[32:35], v[96:99], 0
  v_mfma_f32_16x16x32_bf16 v[140:143], v[32:35], v[112:115], 0
  v_mfma_f32_16x16x32_bf16 v[144:147], v[48:51], v[64:67], 0
  v_mfma_f32_16x16x32_bf16 v[148:151], v[48:51], v[80:83], 0
  v_mfma_f32_16x16x32_bf16 v[152:155], v[48:51], v[96:99], 0
  v_mfma_f32_16x16x32_bf16 v[156:159], v[48:51], v[112:115], 0
  v_mfma_f32_16x16x32_bf16 v[128:131], v[36:39], v[68:71], v[128:131]
  v_mfma_f32_16x16x32_bf16 v[132:135], v[36:39], v[84:87], v[132:135]
  v_mfma_f32_16x16x32_bf16 v[136:139], v[36:39], v[100:103], v[136:139]
  v_mfma_f32_16x16x32_bf16 v[140:143], v[36:39], v[116:119], v[140:143]
  v_mfma_f32_16x16x32_bf16 v[144:147], v[52:55], v[68:71], v[144:147]
  v_mfma_f32_16x16x32_bf16 v[148:151], v[52:55], v[84:87], v[148:151]
  v_mfma_f32_16x16x32_bf16 v[152:155], v[52:55], v[100:103], v[152:155]
  v_mfma_f32_16x16x32_bf16 v[156:159], v[52:55], v[116:119], v[156:159]
  v_mfma_f32_16x16x32_bf16 v[128:131], v[40:43], v[72:75], v[128:131]
  v_mfma_f32_16x16x32_bf16 v[132:135], v[40:43], v[88:91], v[132:135]
  v_mfma_f32_16x16x32_bf16 v[136:139], v[40:43], v[104:107], v[136:139]
  v_mfma_f32_16x16x32_bf16 v[140:143], v[40:43], v[120:123], v[140:143]
  v_mfma_f32_16x16x32_bf16 v[144:147], v[56:59], v[72:75], v[144:147]
  v_mfma_f32_16x16x32_bf16 v[148:151], v[56:59], v[88:91], v[148:151]
  v_mfma_f32_16x16x32_bf16 v[152:155], v[56:59], v[104:107], v[152:155]
  v_mfma_f32_16x16x32_bf16 v[156:159], v[56:59], v[120:123], v[156:159]
  v_mfma_f32_16x16x32_bf16 v[128:131], v[44:47], v[76:79], v[128:131]
  v_mfma_f32_16x16x32_bf16 v[132:135], v[44:47], v[92:95], v[132:135]
  v_mfma_f32_16x16x32_bf16 v[136:139], v[44:47], v[108:111], v[136:139]
  v_mfma_f32_16x16x32_bf16 v[140:143], v[44:47], v[124:127], v[140:143]
  v_mfma_f32_16x16x32_bf16 v[144:147], v[60:63], v[76:79], v[144:147]
  v_mfma_f32_16x16x32_bf16 v[148:151], v[60:63], v[92:95], v[148:151]
  v_mfma_f32_16x16x32_bf16 v[152:155], v[60:63], v[108:111], v[152:155]
  v_mfma_f32_16x16x32_bf16 v[156:159], v[60:63], v[124:127], v[156:159]
  s_nop 7
  s_nop 1
  v_cvt_pk_bf16_f32 v16, v128, v128
  v_and_b32 v16, 0xffff, v16
  v_and_b32 v17, 0x7fffffff, v132
  v_add_u32 v17, 0x8000, v17
  v_max_u32 v17, v17, v16
  v_sub_u32 v17, v17, v16
  v_and_or_b32 v17, v17, s45, v16
  v_bfi_b32 v162, s46, v132, v17
  v_cvt_pk_bf16_f32 v16, v136, v136
  v_and_b32 v16, 0xffff, v16
  v_and_b32 v17, 0x7fffffff, v140
  v_add_u32 v17, 0x8000, v17
  v_max_u32 v17, v17, v16
  v_sub_u32 v17, v17, v16
  v_and_or_b32 v17, v17, s45, v16
  v_bfi_b32 v163, s46, v140, v17
  v_cvt_pk_bf16_f32 v16, v129, v129
  v_and_b32 v16, 0xffff, v16
  v_and_b32 v17, 0x7fffffff, v133
  v_add_u32 v17, 0x8000, v17
  v_max_u32 v17, v17, v16
  v_sub_u32 v17, v17, v16
  v_and_or_b32 v17, v17, s45, v16
  v_bfi_b32 v166, s46, v133, v17
  v_cvt_pk_bf16_f32 v16, v137, v137
  v_and_b32 v16, 0xffff, v16
  v_and_b32 v17, 0x7fffffff, v141
  v_add_u32 v17, 0x8000, v17
  v_max_u32 v17, v17, v16
  v_sub_u32 v17, v17, v16
  v_and_or_b32 v17, v17, s45, v16
  v_bfi_b32 v167, s46, v141, v17
  v_cvt_pk_bf16_f32 v16, v130, v130
  v_and_b32 v16, 0xffff, v16
  v_and_b32 v17, 0x7fffffff, v134
  v_add_u32 v17, 0x8000, v17
  v_max_u32 v17, v17, v16
  v_sub_u32 v17, v17, v16
  v_and_or_b32 v17, v17, s45, v16
  v_bfi_b32 v170, s46, v134, v17
  v_cvt_pk_bf16_f32 v16, v138, v138
  v_and_b32 v16, 0xffff, v16
  v_and_b32 v17, 0x7fffffff, v142
  v_add_u32 v17, 0x8000, v17
  v_max_u32 v17, v17, v16
  v_sub_u32 v17, v17, v16
  v_and_or_b32 v17, v17, s45, v16
  v_bfi_b32 v171, s46, v142, v17
  v_cvt_pk_bf16_f32 v16, v131, v131
  v_and_b32 v16, 0xffff, v16
  v_and_b32 v17, 0x7fffffff, v135
  v_add_u32 v17, 0x8000, v17
  v_max_u32 v17, v17, v16
  v_sub_u32 v17, v17, v16
  v_and_or_b32 v17, v17, s45, v16
  v_bfi_b32 v174, s46, v135, v17
  v_cvt_pk_bf16_f32 v16, v139, v139
  v_and_b32 v16, 0xffff, v16
  v_and_b32 v17, 0x7fffffff, v143
  v_add_u32 v17, 0x8000, v17
  v_max_u32 v17, v17, v16
  v_sub_u32 v17, v17, v16
  v_and_or_b32 v17, v17, s45, v16
  v_bfi_b32 v175, s46, v143, v17
  v_cvt_pk_bf16_f32 v16, v144, v144
  v_and_b32 v16, 0xffff, v16
  v_and_b32 v17, 0x7fffffff, v148
  v_add_u32 v17, 0x8000, v17
  v_max_u32 v17, v17, v16
  v_sub_u32 v17, v17, v16
  v_and_or_b32 v17, v17, s45, v16
  v_bfi_b32 v178, s46, v148, v17
  v_cvt_pk_bf16_f32 v16, v152, v152
  v_and_b32 v16, 0xffff, v16
  v_and_b32 v17, 0x7fffffff, v156
  v_add_u32 v17, 0x8000, v17
  v_max_u32 v17, v17, v16
  v_sub_u32 v17, v17, v16
  v_and_or_b32 v17, v17, s45, v16
  v_bfi_b32 v179, s46, v156, v17
  v_cvt_pk_bf16_f32 v16, v145, v145
  v_and_b32 v16, 0xffff, v16
  v_and_b32 v17, 0x7fffffff, v149
  v_add_u32 v17, 0x8000, v17
  v_max_u32 v17, v17, v16
  v_sub_u32 v17, v17, v16
  v_and_or_b32 v17, v17, s45, v16
  v_bfi_b32 v182, s46, v149, v17
  v_cvt_pk_bf16_f32 v16, v153, v153
  v_and_b32 v16, 0xffff, v16
  v_and_b32 v17, 0x7fffffff, v157
  v_add_u32 v17, 0x8000, v17
  v_max_u32 v17, v17, v16
  v_sub_u32 v17, v17, v16
  v_and_or_b32 v17, v17, s45, v16
  v_bfi_b32 v183, s46, v157, v17
  v_cvt_pk_bf16_f32 v16, v146, v146
  v_and_b32 v16, 0xffff, v16
  v_and_b32 v17, 0x7fffffff, v150
  v_add_u32 v17, 0x8000, v17
  v_max_u32 v17, v17, v16
  v_sub_u32 v17, v17, v16
  v_and_or_b32 v17, v17, s45, v16
  v_bfi_b32 v186, s46, v150, v17
  v_cvt_pk_bf16_f32 v16, v154, v154
  v_and_b32 v16, 0xffff, v16
  v_and_b32 v17, 0x7fffffff, v158
  v_add_u32 v17, 0x8000, v17
  v_max_u32 v17, v17, v16
  v_sub_u32 v17, v17, v16
  v_and_or_b32 v17, v17, s45, v16
  v_bfi_b32 v187, s46, v158, v17
  v_cvt_pk_bf16_f32 v16, v147, v147
  v_and_b32 v16, 0xffff, v16
  v_and_b32 v17, 0x7fffffff, v151
  v_add_u32 v17, 0x8000, v17
  v_max_u32 v17, v17, v16
  v_sub_u32 v17, v17, v16
  v_and_or_b32 v17, v17, s45, v16
  v_bfi_b32 v190, s46, v151, v17
  v_cvt_pk_bf16_f32 v16, v155, v155
  v_and_b32 v16, 0xffff, v16
  v_and_b32 v17, 0x7fffffff, v159
  v_add_u32 v17, 0x8000, v17
  v_max_u32 v17, v17, v16
  v_sub_u32 v17, v17, v16
  v_and_or_b32 v17, v17, s45, v16
  v_bfi_b32 v191, s46, v159, v17
  buffer_store_dwordx4 v[160:163], v14, s[20:23], 0 offen offset:256 sc0 sc1
  buffer_store_dwordx4 v[164:167], v14, s[20:23], 0 offen offset:768 sc0 sc1
  buffer_store_dwordx4 v[168:171], v14, s[20:23], 0 offen offset:1280 sc0 sc1
  buffer_store_dwordx4 v[172:175], v14, s[20:23], 0 offen offset:1792 sc0 sc1
  buffer_store_dwordx4 v[176:179], v15, s[20:23], 0 offen offset:256 sc0 sc1
  buffer_store_dwordx4 v[180:183], v15, s[20:23], 0 offen offset:768 sc0 sc1
  buffer_store_dwordx4 v[184:187], v15, s[20:23], 0 offen offset:1280 sc0 sc1
  buffer_store_dwordx4 v[188:191], v15, s[20:23], 0 offen offset:1792 sc0 sc1
  s_nop 1
K0_DONE:
  s_endpgm
.globl mpnn_main_kernel
.p2align 8
.type mpnn_main_kernel,@function
mpnn_main_kernel:
  s_cmp_ge_u32 s2, 1024
  s_cbranch_scc1 K1_DONE
  s_setprio 3
  s_mov_b32 s15, s2
  s_and_b32 s3, s2, 7
  s_lshl_b32 s3, s3, 7
  s_lshr_b32 s2, s2, 3
  s_add_u32 s2, s2, s3
  s_load_dwordx2 s[4:5], s[0:1], 8
  s_load_dwordx2 s[6:7], s[0:1], 56
  s_load_dwordx2 s[8:9], s[0:1], 72
  s_mul_i32 s3, s2, 6250
  s_add_u32 s10, s3, 1023
  s_lshr_b32 s10, s10, 10
  s_add_u32 s11, s3, 7273
  s_lshr_b32 s11, s11, 10
  s_sub_u32 s11, s11, s10
  s_lshl_b32 s11, s11, 1
  s_lshl_b32 s10, s10, 1
  v_and_b32 v1, 15, v0
  v_bfe_u32 v2, v0, 4, 2
  v_readfirstlane_b32 s12, v0
  s_nop 3
  s_lshr_b32 s12, s12, 6
  s_and_b32 s13, s12, 1
  s_lshr_b32 s14, s12, 1
  s_waitcnt lgkmcnt(0)
  s_mov_b32 s16, s8
  s_and_b32 s17, s9, 0xffff
  s_mov_b32 s18, 15259424
  s_mov_b32 s19, 0x00020000
  s_mov_b32 s20, s4
  s_and_b32 s21, s5, 0xffff
  s_mov_b32 s22, 12800000
  s_mov_b32 s23, 0x00020000
  s_mov_b32 s24, s6
  s_and_b32 s25, s7, 0xffff
  s_mov_b32 s26, 3200000
  s_mov_b32 s27, 0x00020000
  v_mul_u32_u24 v3, 8208, v0
  s_lshl_b32 s28, s2, 3
  s_add_u32 s28, s28, 14454784
  v_mov_b32 v96, 0
  v_mov_b32 v97, 0
  v_mov_b32 v98, 0
  v_cmp_gt_u32 vcc, 98, v0
  s_and_saveexec_b64 s[30:31], vcc
  s_cbranch_execz K1_P0
  buffer_load_dwordx3 v[96:98], v3, s[16:19], s28 offen
K1_P0:
  s_mov_b64 exec, s[30:31]
  s_lshr_b32 s53, s15, 3
  s_mul_i32 s53, s53, 0
  v_lshlrev_b32 v121, 4, v0
  v_lshrrev_b32 v6, 2, v0
  v_and_b32 v7, 3, v0
  v_lshlrev_b32 v7, 1, v7
  v_add_u32 v7, 8, v7
  v_mov_b32 v9, 0x3f80
  v_mov_b32 v10, 0x3f800000
  v_cmp_eq_u32 vcc, v6, v7
  s_nop 1
  v_cndmask_b32 v8, 0, v9, vcc
  v_add_u32 v7, 1, v7
  v_cmp_eq_u32 vcc, v6, v7
  s_nop 1
  v_cndmask_b32 v8, v8, v10, vcc
  v_lshlrev_b32 v6, 2, v0
  v_cmp_gt_u32 vcc, 100, v0
  s_and_saveexec_b64 s[30:31], vcc
  ds_write_b32 v6, v8 offset:34112
  s_mov_b64 exec, s[30:31]
  v_mov_b32 v12, 0
  v_mov_b32 v13, 0
  v_mov_b32 v14, 0
  v_mov_b32 v15, 0
  v_lshlrev_b32 v6, 4, v0
  v_cmp_gt_u32 vcc, 204, v0
  s_and_saveexec_b64 s[30:31], vcc
  ds_write_b128 v6, v[12:15] offset:34512
  s_mov_b64 exec, s[30:31]
  s_lshl_b32 s33, s13, 8
  v_lshlrev_b32 v48, 4, v1
  v_add_u32 v48, s33, v48
  v_lshlrev_b32 v50, 7, v2
  v_sub_u32 v50, 34496, v50
  v_cmp_gt_u32 vcc, 2, v2
  v_mov_b32 v6, 512
  s_nop 0
  v_cndmask_b32 v49, 16, 0, vcc
  v_cndmask_b32 v123, 0, v6, vcc
  s_mul_i32 s33, s12, 816
  s_add_u32 s33, s33, 34512
  v_lshlrev_b32 v51, 1, v1
  v_add_u32 v51, s33, v51
  v_mul_u32_u24 v52, 48, v1
  v_lshl_add_u32 v52, v2, 3, v52
  v_add_u32 v52, s33, v52
  v_mov_b32 v55, 0x3f80
  v_mov_b32 v15, 0xffff0000
  s_mov_b32 s40, 0xfffffe00
  s_mov_b32 s45, 0xfffffe00
  s_mov_b32 s41, 0xffff0000
  s_waitcnt vmcnt(0)
  v_and_b32 v4, 0xffff, v96
  v_lshrrev_b32 v5, 16, v96
  v_lshl_or_b32 v5, v97, 16, v5
  v_lshrrev_b32 v3, 16, v97
  v_and_b32 v11, 0xffff, v98
  s_mov_b32 s62, 1
K1_ROUND:
  v_sub_u32 v6, v11, v4
  v_min_u32 v7, 20, v6
  v_lshlrev_b32 v96, 14, v0
  v_lshl_add_u32 v96, v4, 2, v96
  s_mov_b32 s33, 12849152
  s_mov_b64 s[30:31], exec
  v_cmp_lt_u32 vcc, 0, v7
  s_and_b64 exec, exec, vcc
  s_cbranch_execz K1_R1
  buffer_load_dwordx4 v[56:59], v96, s[16:19], s33 offen offset:0
  v_cmp_lt_u32 vcc, 4, v7
  s_and_b64 exec, exec, vcc
  s_cbranch_execz K1_R1
  buffer_load_dwordx4 v[60:63], v96, s[16:19], s33 offen offset:16
  v_cmp_lt_u32 vcc, 8, v7
  s_and_b64 exec, exec, vcc
  s_cbranch_execz K1_R1
  buffer_load_dwordx4 v[64:67], v96, s[16:19], s33 offen offset:32
  v_cmp_lt_u32 vcc, 12, v7
  s_and_b64 exec, exec, vcc
  s_cbranch_execz K1_R1
  buffer_load_dwordx4 v[68:71], v96, s[16:19], s33 offen offset:48
  v_cmp_lt_u32 vcc, 16, v7
  s_and_b64 exec, exec, vcc
  s_cbranch_execz K1_R1
  buffer_load_dwordx4 v[72:75], v96, s[16:19], s33 offen offset:64
K1_R1:
  s_mov_b64 exec, s[30:31]
  s_cmp_eq_u32 s62, 0
  s_cbranch_scc1 K1_R2
  v_lshlrev_b32 v109, 11, v2
  v_lshl_add_u32 v109, v1, 3, v109
  s_lshl_b32 s33, s10, 8
  s_sub_u32 s33, s33, 4096
  v_mov_b32 v110, s33
  v_mov_b32 v111, 3211264
  v_cmp_gt_u32 vcc, 2, v2
  s_lshl_b32 s34, s13, 7
  s_add_u32 s34, s34, 6422528
  v_cndmask_b32 v110, v110, v111, vcc
  v_add_u32 v109, v109, v110
  buffer_load_dwordx2 v[76:77], v109, s[16:19], s34 offen offset:0
  buffer_load_dwordx2 v[78:79], v109, s[16:19], s34 offen offset:256
  buffer_load_dwordx2 v[80:81], v109, s[16:19], s34 offen offset:512
  buffer_load_dwordx2 v[82:83], v109, s[16:19], s34 offen offset:768
  buffer_load_dwordx2 v[84:85], v109, s[16:19], s34 offen offset:1024
  buffer_load_dwordx2 v[86:87], v109, s[16:19], s34 offen offset:1280
  buffer_load_dwordx2 v[88:89], v109, s[16:19], s34 offen offset:1536
  buffer_load_dwordx2 v[90:91], v109, s[16:19], s34 offen offset:1792
  v_lshlrev_b32 v110, 10, v2
  v_lshl_add_u32 v110, v1, 3, v110
  s_lshl_b32 s33, s10, 8
  s_lshl_b32 s34, s13, 7
  s_add_u32 s33, s33, s34
  s_add_u32 s33, s33, 9637888
  buffer_load_dwordx2 v[92:93], v110, s[16:19], s33 offen offset:0
  buffer_load_dwordx2 v[94:95], v110, s[16:19], s33 offen offset:256
  buffer_load_dwordx2 v[116:117], v110, s[16:19], s33 offen offset:512
  buffer_load_dwordx2 v[118:119], v110, s[16:19], s33 offen offset:768
K1_R2:
  v_and_b32 v100, 0xffff, v5
  v_lshrrev_b32 v101, 16, v5
  v_mov_b32 v102, v3
  v_max_u32 v100, v100, v4
  v_sub_u32 v100, v100, v4
  v_min_u32 v100, v100, v7
  v_max_u32 v101, v101, v4
  v_sub_u32 v101, v101, v4
  v_min_u32 v101, v101, v7
  v_max_u32 v102, v102, v4
  v_sub_u32 v102, v102, v4
  v_min_u32 v102, v102, v7
  v_sub_u32 v8, v101, v100
  v_lshl_or_b32 v8, v8, 16, v100
  v_sub_u32 v9, v102, v101
  v_sub_u32 v10, v7, v102
  v_lshl_or_b32 v9, v10, 16, v9
  v_mov_b32 v103, v8
  v_mov_b32 v104, v9
  v_mov_b32 v10, 0
  s_nop 1
  v_mov_b32_dpp v10, v8 row_shr:1 row_mask:0xf bank_mask:0xf
  v_add_u32 v8, v8, v10
  v_mov_b32 v10, 0
  s_nop 1
  v_mov_b32_dpp v10, v8 row_shr:2 row_mask:0xf bank_mask:0xf
  v_add_u32 v8, v8, v10
  v_mov_b32 v10, 0
  s_nop 1
  v_mov_b32_dpp v10, v8 row_shr:4 row_mask:0xf bank_mask:0xf
  v_add_u32 v8, v8, v10
  v_mov_b32 v10, 0
  s_nop 1
  v_mov_b32_dpp v10, v8 row_shr:8 row_mask:0xf bank_mask:0xf
  v_add_u32 v8, v8, v10
  v_mov_b32 v10, 0
  s_nop 1
  v_mov_b32_dpp v10, v8 row_bcast:15 row_mask:0xa bank_mask:0xf
  v_add_u32 v8, v8, v10
  v_mov_b32 v10, 0
  s_nop 1
  v_mov_b32_dpp v10, v8 row_bcast:31 row_mask:0xc bank_mask:0xf
  v_add_u32 v8, v8, v10
  v_mov_b32 v10, 0
  s_nop 1
  v_mov_b32_dpp v10, v9 row_shr:1 row_mask:0xf bank_mask:0xf
  v_add_u32 v9, v9, v10
  v_mov_b32 v10, 0
  s_nop 1
  v_mov_b32_dpp v10, v9 row_shr:2 row_mask:0xf bank_mask:0xf
  v_add_u32 v9, v9, v10
  v_mov_b32 v10, 0
  s_nop 1
  v_mov_b32_dpp v10, v9 row_shr:4 row_mask:0xf bank_mask:0xf
  v_add_u32 v9, v9, v10
  v_mov_b32 v10, 0
  s_nop 1
  v_mov_b32_dpp v10, v9 row_shr:8 row_mask:0xf bank_mask:0xf
  v_add_u32 v9, v9, v10
  v_mov_b32 v10, 0
  s_nop 1
  v_mov_b32_dpp v10, v9 row_bcast:15 row_mask:0xa bank_mask:0xf
  v_add_u32 v9, v9, v10
  v_mov_b32 v10, 0
  s_nop 1
  v_mov_b32_dpp v10, v9 row_bcast:31 row_mask:0xc bank_mask:0xf
  v_add_u32 v9, v9, v10
  v_cmp_lt_u32 vcc, 20, v6
  s_cmp_lg_u64 vcc, 0
  s_cselect_b32 s34, 0x80000000, 0
  v_or_b32 v98, s34, v8
  v_mov_b32 v99, v9
  s_lshl_b32 s35, s12, 3
  v_mov_b32 v97, s35
  v_and_b32 v13, 63, v0
  v_cmp_eq_u32 vcc, 63, v13
  s_and_saveexec_b64 s[30:31], vcc
  ds_write_b64 v97, v[98:99] offset:37776
  s_mov_b64 exec, s[30:31]
  s_waitcnt lgkmcnt(0)
  s_barrier
  ds_read_b128 v[112:115], v12 offset:37776
  ds_read_b128 v[96:99], v12 offset:37792
  s_waitcnt lgkmcnt(0)
  v_readfirstlane_b32 s54, v112
  v_readfirstlane_b32 s55, v113
  v_readfirstlane_b32 s56, v114
  v_readfirstlane_b32 s57, v115
  v_readfirstlane_b32 s58, v96
  v_readfirstlane_b32 s59, v97
  v_readfirstlane_b32 s60, v98
  v_readfirstlane_b32 s61, v99
  s_nop 3
  s_or_b32 s36, s54, s56
  s_or_b32 s36, s36, s58
  s_or_b32 s36, s36, s60
  s_and_b32 s54, s54, 0x7fffffff
  s_and_b32 s56, s56, 0x7fffffff
  s_and_b32 s58, s58, 0x7fffffff
  s_and_b32 s60, s60, 0x7fffffff
  s_add_u32 s42, s54, s56
  s_add_u32 s42, s42, s58
  s_add_u32 s42, s42, s60
  s_add_u32 s43, s55, s57
  s_add_u32 s43, s43, s59
  s_add_u32 s43, s43, s61
  s_cmp_gt_u32 s12, 0
  s_cselect_b32 s54, s54, 0
  s_cselect_b32 s55, s55, 0
  s_cmp_gt_u32 s12, 1
  s_cselect_b32 s56, s56, 0
  s_cselect_b32 s57, s57, 0
  s_cmp_gt_u32 s12, 2
  s_cselect_b32 s58, s58, 0
  s_cselect_b32 s59, s59, 0
  s_add_u32 s54, s54, s56
  s_add_u32 s54, s54, s58
  s_add_u32 s55, s55, s57
  s_add_u32 s55, s55, s59
  s_and_b32 s56, s42, 0xffff
  s_lshr_b32 s57, s42, 16
  s_add_u32 s57, s57, s56
  s_and_b32 s58, s43, 0xffff
  s_add_u32 s58, s58, s57
  s_lshr_b32 s37, s43, 16
  s_add_u32 s37, s37, s58
  v_sub_u32 v8, v8, v103
  v_add_u32 v8, s54, v8
  v_sub_u32 v9, v9, v104
  v_add_u32 v9, s55, v9
  v_and_b32 v105, 0xffff, v8
  v_lshlrev_b32 v105, 2, v105
  v_lshrrev_b32 v106, 16, v8
  v_add_u32 v106, s56, v106
  v_sub_u32 v106, v106, v100
  v_lshlrev_b32 v106, 2, v106
  v_and_b32 v107, 0xffff, v9
  v_add_u32 v107, s57, v107
  v_sub_u32 v107, v107, v101
  v_lshlrev_b32 v107, 2, v107
  v_lshrrev_b32 v108, 16, v9
  v_add_u32 v108, s58, v108
  v_sub_u32 v108, v108, v102
  v_lshlrev_b32 v108, 2, v108
  v_lshlrev_b32 v97, 17, v0
  v_add_u32 v98, s37, v0
  v_lshlrev_b32 v98, 2, v98
  v_mov_b32 v13, 16
  ds_write_b32 v98, v13 offset:0
  ds_write_b32 v98, v12 offset:8864
  s_cmp_eq_u32 s62, 0
  s_cbranch_scc1 K1_R3
  s_waitcnt vmcnt(12)
  s_branch K1_R4
K1_R3:
  s_waitcnt vmcnt(0)
K1_R4:
  v_cmp_lt_u32 vcc, 0, v7
  s_and_b64 exec, exec, vcc
  s_cbranch_execz K1_LD
  v_cmp_lt_u32 vcc, 0, v102
  v_cmp_lt_u32 s[54:55], 0, v101
  v_cmp_lt_u32 s[56:57], 0, v100
  v_lshrrev_b32 v13, 9, v56
  v_cndmask_b32 v98, v108, v107, vcc
  v_and_b32 v13, s40, v13
  v_cndmask_b32 v98, v98, v106, s[54:55]
  v_and_or_b32 v13, v56, 31, v13
  v_cndmask_b32 v98, v98, v105, s[56:57]
  v_bfe_u32 v14, v56, 6, 12
  v_lshl_add_u32 v14, v14, 5, v97
  ds_write_b32 v98, v13 offset:0
  ds_write_b32 v98, v14 offset:8864
  v_cmp_lt_u32 vcc, 1, v7
  s_and_b64 exec, exec, vcc
  s_cbranch_execz K1_LD
  v_cmp_lt_u32 vcc, 1, v102
  v_cmp_lt_u32 s[54:55], 1, v101
  v_cmp_lt_u32 s[56:57], 1, v100
  v_lshrrev_b32 v13, 9, v57
  v_cndmask_b32 v98, v108, v107, vcc
  v_and_b32 v13, s40, v13
  v_cndmask_b32 v98, v98, v106, s[54:55]
  v_and_or_b32 v13, v57, 31, v13
  v_cndmask_b32 v98, v98, v105, s[56:57]
  v_bfe_u32 v14, v57, 6, 12
  v_lshl_add_u32 v14, v14, 5, v97
  ds_write_b32 v98, v13 offset:4
  ds_write_b32 v98, v14 offset:8868
  v_cmp_lt_u32 vcc, 2, v7
  s_and_b64 exec, exec, vcc
  s_cbranch_execz K1_LD
  v_cmp_lt_u32 vcc, 2, v102
  v_cmp_lt_u32 s[54:55], 2, v101
  v_cmp_lt_u32 s[56:57], 2, v100
  v_lshrrev_b32 v13, 9, v58
  v_cndmask_b32 v98, v108, v107, vcc
  v_and_b32 v13, s40, v13
  v_cndmask_b32 v98, v98, v106, s[54:55]
  v_and_or_b32 v13, v58, 31, v13
  v_cndmask_b32 v98, v98, v105, s[56:57]
  v_bfe_u32 v14, v58, 6, 12
  v_lshl_add_u32 v14, v14, 5, v97
  ds_write_b32 v98, v13 offset:8
  ds_write_b32 v98, v14 offset:8872
  v_cmp_lt_u32 vcc, 3, v7
  s_and_b64 exec, exec, vcc
  s_cbranch_execz K1_LD
  v_cmp_lt_u32 vcc, 3, v102
  v_cmp_lt_u32 s[54:55], 3, v101
  v_cmp_lt_u32 s[56:57], 3, v100
  v_lshrrev_b32 v13, 9, v59
  v_cndmask_b32 v98, v108, v107, vcc
  v_and_b32 v13, s40, v13
  v_cndmask_b32 v98, v98, v106, s[54:55]
  v_and_or_b32 v13, v59, 31, v13
  v_cndmask_b32 v98, v98, v105, s[56:57]
  v_bfe_u32 v14, v59, 6, 12
  v_lshl_add_u32 v14, v14, 5, v97
  ds_write_b32 v98, v13 offset:12
  ds_write_b32 v98, v14 offset:8876
  v_cmp_lt_u32 vcc, 4, v7
  s_and_b64 exec, exec, vcc
  s_cbranch_execz K1_LD
  v_cmp_lt_u32 vcc, 4, v102
  v_cmp_lt_u32 s[54:55], 4, v101
  v_cmp_lt_u32 s[56:57], 4, v100
  v_lshrrev_b32 v13, 9, v60
  v_cndmask_b32 v98, v108, v107, vcc
  v_and_b32 v13, s40, v13
  v_cndmask_b32 v98, v98, v106, s[54:55]
  v_and_or_b32 v13, v60, 31, v13
  v_cndmask_b32 v98, v98, v105, s[56:57]
  v_bfe_u32 v14, v60, 6, 12
  v_lshl_add_u32 v14, v14, 5, v97
  ds_write_b32 v98, v13 offset:16
  ds_write_b32 v98, v14 offset:8880
  v_cmp_lt_u32 vcc, 5, v7
  s_and_b64 exec, exec, vcc
  s_cbranch_execz K1_LD
  v_cmp_lt_u32 vcc, 5, v102
  v_cmp_lt_u32 s[54:55], 5, v101
  v_cmp_lt_u32 s[56:57], 5, v100
  v_lshrrev_b32 v13, 9, v61
  v_cndmask_b32 v98, v108, v107, vcc
  v_and_b32 v13, s40, v13
  v_cndmask_b32 v98, v98, v106, s[54:55]
  v_and_or_b32 v13, v61, 31, v13
  v_cndmask_b32 v98, v98, v105, s[56:57]
  v_bfe_u32 v14, v61, 6, 12
  v_lshl_add_u32 v14, v14, 5, v97
  ds_write_b32 v98, v13 offset:20
  ds_write_b32 v98, v14 offset:8884
  v_cmp_lt_u32 vcc, 6, v7
  s_and_b64 exec, exec, vcc
  s_cbranch_execz K1_LD
  v_cmp_lt_u32 vcc, 6, v102
  v_cmp_lt_u32 s[54:55], 6, v101
  v_cmp_lt_u32 s[56:57], 6, v100
  v_lshrrev_b32 v13, 9, v62
  v_cndmask_b32 v98, v108, v107, vcc
  v_and_b32 v13, s40, v13
  v_cndmask_b32 v98, v98, v106, s[54:55]
  v_and_or_b32 v13, v62, 31, v13
  v_cndmask_b32 v98, v98, v105, s[56:57]
  v_bfe_u32 v14, v62, 6, 12
  v_lshl_add_u32 v14, v14, 5, v97
  ds_write_b32 v98, v13 offset:24
  ds_write_b32 v98, v14 offset:8888
  v_cmp_lt_u32 vcc, 7, v7
  s_and_b64 exec, exec, vcc
  s_cbranch_execz K1_LD
  v_cmp_lt_u32 vcc, 7, v102
  v_cmp_lt_u32 s[54:55], 7, v101
  v_cmp_lt_u32 s[56:57], 7, v100
  v_lshrrev_b32 v13, 9, v63
  v_cndmask_b32 v98, v108, v107, vcc
  v_and_b32 v13, s40, v13
  v_cndmask_b32 v98, v98, v106, s[54:55]
  v_and_or_b32 v13, v63, 31, v13
  v_cndmask_b32 v98, v98, v105, s[56:57]
  v_bfe_u32 v14, v63, 6, 12
  v_lshl_add_u32 v14, v14, 5, v97
  ds_write_b32 v98, v13 offset:28
  ds_write_b32 v98, v14 offset:8892
  v_cmp_lt_u32 vcc, 8, v7
  s_and_b64 exec, exec, vcc
  s_cbranch_execz K1_LD
  v_cmp_lt_u32 vcc, 8, v102
  v_cmp_lt_u32 s[54:55], 8, v101
  v_cmp_lt_u32 s[56:57], 8, v100
  v_lshrrev_b32 v13, 9, v64
  v_cndmask_b32 v98, v108, v107, vcc
  v_and_b32 v13, s40, v13
  v_cndmask_b32 v98, v98, v106, s[54:55]
  v_and_or_b32 v13, v64, 31, v13
  v_cndmask_b32 v98, v98, v105, s[56:57]
  v_bfe_u32 v14, v64, 6, 12
  v_lshl_add_u32 v14, v14, 5, v97
  ds_write_b32 v98, v13 offset:32
  ds_write_b32 v98, v14 offset:8896
  v_cmp_lt_u32 vcc, 9, v7
  s_and_b64 exec, exec, vcc
  s_cbranch_execz K1_LD
  v_cmp_lt_u32 vcc, 9, v102
  v_cmp_lt_u32 s[54:55], 9, v101
  v_cmp_lt_u32 s[56:57], 9, v100
  v_lshrrev_b32 v13, 9, v65
  v_cndmask_b32 v98, v108, v107, vcc
  v_and_b32 v13, s40, v13
  v_cndmask_b32 v98, v98, v106, s[54:55]
  v_and_or_b32 v13, v65, 31, v13
  v_cndmask_b32 v98, v98, v105, s[56:57]
  v_bfe_u32 v14, v65, 6, 12
  v_lshl_add_u32 v14, v14, 5, v97
  ds_write_b32 v98, v13 offset:36
  ds_write_b32 v98, v14 offset:8900
  v_cmp_lt_u32 vcc, 10, v7
  s_and_b64 exec, exec, vcc
  s_cbranch_execz K1_LD
  v_cmp_lt_u32 vcc, 10, v102
  v_cmp_lt_u32 s[54:55], 10, v101
  v_cmp_lt_u32 s[56:57], 10, v100
  v_lshrrev_b32 v13, 9, v66
  v_cndmask_b32 v98, v108, v107, vcc
  v_and_b32 v13, s40, v13
  v_cndmask_b32 v98, v98, v106, s[54:55]
  v_and_or_b32 v13, v66, 31, v13
  v_cndmask_b32 v98, v98, v105, s[56:57]
  v_bfe_u32 v14, v66, 6, 12
  v_lshl_add_u32 v14, v14, 5, v97
  ds_write_b32 v98, v13 offset:40
  ds_write_b32 v98, v14 offset:8904
  v_cmp_lt_u32 vcc, 11, v7
  s_and_b64 exec, exec, vcc
  s_cbranch_execz K1_LD
  v_cmp_lt_u32 vcc, 11, v102
  v_cmp_lt_u32 s[54:55], 11, v101
  v_cmp_lt_u32 s[56:57], 11, v100
  v_lshrrev_b32 v13, 9, v67
  v_cndmask_b32 v98, v108, v107, vcc
  v_and_b32 v13, s40, v13
  v_cndmask_b32 v98, v98, v106, s[54:55]
  v_and_or_b32 v13, v67, 31, v13
  v_cndmask_b32 v98, v98, v105, s[56:57]
  v_bfe_u32 v14, v67, 6, 12
  v_lshl_add_u32 v14, v14, 5, v97
  ds_write_b32 v98, v13 offset:44
  ds_write_b32 v98, v14 offset:8908
  v_cmp_lt_u32 vcc, 12, v7
  s_and_b64 exec, exec, vcc
  s_cbranch_execz K1_LD
  v_cmp_lt_u32 vcc, 12, v102
  v_cmp_lt_u32 s[54:55], 12, v101
  v_cmp_lt_u32 s[56:57], 12, v100
  v_lshrrev_b32 v13, 9, v68
  v_cndmask_b32 v98, v108, v107, vcc
  v_and_b32 v13, s40, v13
  v_cndmask_b32 v98, v98, v106, s[54:55]
  v_and_or_b32 v13, v68, 31, v13
  v_cndmask_b32 v98, v98, v105, s[56:57]
  v_bfe_u32 v14, v68, 6, 12
  v_lshl_add_u32 v14, v14, 5, v97
  ds_write_b32 v98, v13 offset:48
  ds_write_b32 v98, v14 offset:8912
  v_cmp_lt_u32 vcc, 13, v7
  s_and_b64 exec, exec, vcc
  s_cbranch_execz K1_LD
  v_cmp_lt_u32 vcc, 13, v102
  v_cmp_lt_u32 s[54:55], 13, v101
  v_cmp_lt_u32 s[56:57], 13, v100
  v_lshrrev_b32 v13, 9, v69
  v_cndmask_b32 v98, v108, v107, vcc
  v_and_b32 v13, s40, v13
  v_cndmask_b32 v98, v98, v106, s[54:55]
  v_and_or_b32 v13, v69, 31, v13
  v_cndmask_b32 v98, v98, v105, s[56:57]
  v_bfe_u32 v14, v69, 6, 12
  v_lshl_add_u32 v14, v14, 5, v97
  ds_write_b32 v98, v13 offset:52
  ds_write_b32 v98, v14 offset:8916
  v_cmp_lt_u32 vcc, 14, v7
  s_and_b64 exec, exec, vcc
  s_cbranch_execz K1_LD
  v_cmp_lt_u32 vcc, 14, v102
  v_cmp_lt_u32 s[54:55], 14, v101
  v_cmp_lt_u32 s[56:57], 14, v100
  v_lshrrev_b32 v13, 9, v70
  v_cndmask_b32 v98, v108, v107, vcc
  v_and_b32 v13, s40, v13
  v_cndmask_b32 v98, v98, v106, s[54:55]
  v_and_or_b32 v13, v70, 31, v13
  v_cndmask_b32 v98, v98, v105, s[56:57]
  v_bfe_u32 v14, v70, 6, 12
  v_lshl_add_u32 v14, v14, 5, v97
  ds_write_b32 v98, v13 offset:56
  ds_write_b32 v98, v14 offset:8920
  v_cmp_lt_u32 vcc, 15, v7
  s_and_b64 exec, exec, vcc
  s_cbranch_execz K1_LD
  v_cmp_lt_u32 vcc, 15, v102
  v_cmp_lt_u32 s[54:55], 15, v101
  v_cmp_lt_u32 s[56:57], 15, v100
  v_lshrrev_b32 v13, 9, v71
  v_cndmask_b32 v98, v108, v107, vcc
  v_and_b32 v13, s40, v13
  v_cndmask_b32 v98, v98, v106, s[54:55]
  v_and_or_b32 v13, v71, 31, v13
  v_cndmask_b32 v98, v98, v105, s[56:57]
  v_bfe_u32 v14, v71, 6, 12
  v_lshl_add_u32 v14, v14, 5, v97
  ds_write_b32 v98, v13 offset:60
  ds_write_b32 v98, v14 offset:8924
  v_cmp_lt_u32 vcc, 16, v7
  s_and_b64 exec, exec, vcc
  s_cbranch_execz K1_LD
  v_cmp_lt_u32 vcc, 16, v102
  v_cmp_lt_u32 s[54:55], 16, v101
  v_cmp_lt_u32 s[56:57], 16, v100
  v_lshrrev_b32 v13, 9, v72
  v_cndmask_b32 v98, v108, v107, vcc
  v_and_b32 v13, s40, v13
  v_cndmask_b32 v98, v98, v106, s[54:55]
  v_and_or_b32 v13, v72, 31, v13
  v_cndmask_b32 v98, v98, v105, s[56:57]
  v_bfe_u32 v14, v72, 6, 12
  v_lshl_add_u32 v14, v14, 5, v97
  ds_write_b32 v98, v13 offset:64
  ds_write_b32 v98, v14 offset:8928
  v_cmp_lt_u32 vcc, 17, v7
  s_and_b64 exec, exec, vcc
  s_cbranch_execz K1_LD
  v_cmp_lt_u32 vcc, 17, v102
  v_cmp_lt_u32 s[54:55], 17, v101
  v_cmp_lt_u32 s[56:57], 17, v100
  v_lshrrev_b32 v13, 9, v73
  v_cndmask_b32 v98, v108, v107, vcc
  v_and_b32 v13, s40, v13
  v_cndmask_b32 v98, v98, v106, s[54:55]
  v_and_or_b32 v13, v73, 31, v13
  v_cndmask_b32 v98, v98, v105, s[56:57]
  v_bfe_u32 v14, v73, 6, 12
  v_lshl_add_u32 v14, v14, 5, v97
  ds_write_b32 v98, v13 offset:68
  ds_write_b32 v98, v14 offset:8932
  v_cmp_lt_u32 vcc, 18, v7
  s_and_b64 exec, exec, vcc
  s_cbranch_execz K1_LD
  v_cmp_lt_u32 vcc, 18, v102
  v_cmp_lt_u32 s[54:55], 18, v101
  v_cmp_lt_u32 s[56:57], 18, v100
  v_lshrrev_b32 v13, 9, v74
  v_cndmask_b32 v98, v108, v107, vcc
  v_and_b32 v13, s40, v13
  v_cndmask_b32 v98, v98, v106, s[54:55]
  v_and_or_b32 v13, v74, 31, v13
  v_cndmask_b32 v98, v98, v105, s[56:57]
  v_bfe_u32 v14, v74, 6, 12
  v_lshl_add_u32 v14, v14, 5, v97
  ds_write_b32 v98, v13 offset:72
  ds_write_b32 v98, v14 offset:8936
  v_cmp_lt_u32 vcc, 19, v7
  s_and_b64 exec, exec, vcc
  s_cbranch_execz K1_LD
  v_cmp_lt_u32 vcc, 19, v102
  v_cmp_lt_u32 s[54:55], 19, v101
  v_cmp_lt_u32 s[56:57], 19, v100
  v_lshrrev_b32 v13, 9, v75
  v_cndmask_b32 v98, v108, v107, vcc
  v_and_b32 v13, s40, v13
  v_cndmask_b32 v98, v98, v106, s[54:55]
  v_and_or_b32 v13, v75, 31, v13
  v_cndmask_b32 v98, v98, v105, s[56:57]
  v_bfe_u32 v14, v75, 6, 12
  v_lshl_add_u32 v14, v14, 5, v97
  ds_write_b32 v98, v13 offset:76
  ds_write_b32 v98, v14 offset:8940
K1_LD:
  s_mov_b64 exec, -1
  v_add_u32 v4, v4, v7
  s_waitcnt lgkmcnt(0)
  s_barrier
  s_cmp_eq_u32 s62, 0
  s_cbranch_scc1 K1_P3
  s_mov_b32 s62, 0
  s_waitcnt vmcnt(0)
  s_mov_b32 s33, 0x05040100
  s_mov_b32 s34, 0x07060302
  v_perm_b32 v16, v78, v76, s33
  v_perm_b32 v17, v82, v80, s33
  v_perm_b32 v18, v86, v84, s33
  v_perm_b32 v19, v90, v88, s33
  v_perm_b32 v20, v78, v76, s34
  v_perm_b32 v21, v82, v80, s34
  v_perm_b32 v22, v86, v84, s34
  v_perm_b32 v23, v90, v88, s34
  v_perm_b32 v24, v79, v77, s33
  v_perm_b32 v25, v83, v81, s33
  v_perm_b32 v26, v87, v85, s33
  v_perm_b32 v27, v91, v89, s33
  v_perm_b32 v28, v79, v77, s34
  v_perm_b32 v29, v83, v81, s34
  v_perm_b32 v30, v87, v85, s34
  v_perm_b32 v31, v91, v89, s34
  s_cmp_lg_u32 s14, 0
  s_cbranch_scc1 K1_P2
  v_lshlrev_b32 v32, 16, v92
  v_and_b32 v36, s41, v92
  v_lshlrev_b32 v40, 16, v93
  v_and_b32 v44, s41, v93
  v_lshlrev_b32 v33, 16, v94
  v_and_b32 v37, s41, v94
  v_lshlrev_b32 v41, 16, v95
  v_and_b32 v45, s41, v95
  v_lshlrev_b32 v34, 16, v116
  v_and_b32 v38, s41, v116
  v_lshlrev_b32 v42, 16, v117
  v_and_b32 v46, s41, v117
  v_lshlrev_b32 v35, 16, v118
  v_and_b32 v39, s41, v118
  v_lshlrev_b32 v43, 16, v119
  v_and_b32 v47, s41, v119
  s_branch K1_P3
K1_P2:
  v_mov_b32 v32, 0
  v_mov_b32 v33, 0
  v_mov_b32 v34, 0
  v_mov_b32 v35, 0
  v_mov_b32 v36, 0
  v_mov_b32 v37, 0
  v_mov_b32 v38, 0
  v_mov_b32 v39, 0
  v_mov_b32 v40, 0
  v_mov_b32 v41, 0
  v_mov_b32 v42, 0
  v_mov_b32 v43, 0
  v_mov_b32 v44, 0
  v_mov_b32 v45, 0
  v_mov_b32 v46, 0
  v_mov_b32 v47, 0
K1_P3:
  s_add_u32 s38, s37, 15
  s_lshr_b32 s38, s38, 4
  s_mov_b32 s39, s14
  s_cmp_ge_u32 s39, s38
  s_cbranch_scc1 K1_RDONE
  s_lshl_b32 s33, s14, 6
  v_lshlrev_b32 v53, 2, v1
  v_add_u32 v53, s33, v53
  v_lshlrev_b32 v54, 4, v2
  v_add_u32 v54, s33, v54
  s_lshl_b32 s33, s12, 12
  s_add_u32 s33, s33, 17728
  s_mov_b32 s48, s33
  v_lshlrev_b32 v122, 5, v1
  v_lshl_add_u32 v122, v2, 4, v122
  v_add_u32 v122, s33, v122
  v_cmp_gt_u32 vcc, 2, v2
  s_nop 1
  v_cndmask_b32 v122, v50, v122, vcc
  v_bfe_u32 v124, v0, 5, 1
  v_lshlrev_b32 v124, 7, v124
  v_bfe_u32 v6, v0, 1, 4
  v_lshl_add_u32 v124, v6, 2, v124
  s_lshl_b32 s33, s14, 6
  v_add_u32 v124, s33, v124
  v_and_b32 v125, 1, v0
  v_lshlrev_b32 v125, 4, v125
  s_mov_b32 s50, 0
  s_mul_i32 s46, s38, 0x5556
  s_lshr_b32 s46, s46, 16
  s_lshl_b32 s47, s46, 1
  s_mov_b32 s52, 0
  ds_read_b32 v100, v53 offset:0
  ds_read_b128 v[102:105], v54 offset:0
  v_add_u32 v53, 128, v53
  v_add_u32 v54, 128, v54
  ds_read_b32 v10, v53 offset:0
  ds_read_b128 v[6:9], v54 offset:0
  v_add_u32 v53, 128, v53
  v_add_u32 v54, 128, v54
  ds_read_b32 v101, v124 offset:8864
  v_add_u32 v124, 256, v124
  s_waitcnt lgkmcnt(0)
  s_add_u32 s51, s48, s50
  s_mov_b32 m0, s51
  s_add_u32 s50, s50, 1024
  s_and_b32 s50, s50, 4095
  v_add_u32 v101, v101, v125
  buffer_load_dwordx4 v101, s[20:23], 0 offen lds
  ds_read_b32 v101, v124 offset:8864
  v_add_u32 v124, 256, v124
  s_waitcnt lgkmcnt(0)
  s_add_u32 s51, s48, s50
  s_mov_b32 m0, s51
  s_add_u32 s50, s50, 1024
  s_and_b32 s50, s50, 4095
  v_add_u32 v101, v101, v125
  buffer_load_dwordx4 v101, s[20:23], 0 offen lds
  ds_read_b32 v101, v124 offset:8864
  v_add_u32 v124, 256, v124
  v_and_or_b32 v102, v102, s45, v48
  buffer_load_dwordx4 v[56:59], v102, s[16:19], 0 offen
  v_and_or_b32 v103, v103, s45, v48
  buffer_load_dwordx4 v[60:63], v103, s[16:19], 0 offen
  v_and_or_b32 v104, v104, s45, v48
  buffer_load_dwordx4 v[64:67], v104, s[16:19], 0 offen
  v_and_or_b32 v105, v105, s45, v48
  buffer_load_dwordx4 v[68:71], v105, s[16:19], 0 offen
  v_and_b32 v100, 31, v100
  v_mad_u32_u24 v96, v100, 48, v51
  v_mad_u32_u24 v97, v100, v49, v122
  v_mad_u32_u24 v97, v123, s52, v97
  s_add_u32 s52, s52, 1
  s_and_b32 s52, s52, 7
  s_setprio 2
  s_waitcnt vmcnt(5)
  s_mov_b64 exec, 0xffff
  ds_write_b16 v96, v55
  s_mov_b64 exec, -1
  ds_read_b64 v[98:99], v52
  s_mov_b64 exec, 0xffff
  ds_write_b16 v96, v12
  s_mov_b64 exec, -1
  ds_read_b128 v[88:91], v97
K1_LOOP:
  s_cmp_lt_u32 s39, s46
  s_cbranch_scc1 K1_PR
  s_setprio 1
  s_cmp_lt_u32 s39, s47
  s_cbranch_scc1 K1_PR
  s_setprio 0
K1_PR:
  s_waitcnt lgkmcnt(0)
  v_and_or_b32 v6, v6, s45, v48
  buffer_load_dwordx4 v[72:75], v6, s[16:19], 0 offen
  v_and_or_b32 v7, v7, s45, v48
  buffer_load_dwordx4 v[76:79], v7, s[16:19], 0 offen
  v_and_or_b32 v8, v8, s45, v48
  buffer_load_dwordx4 v[80:83], v8, s[16:19], 0 offen
  v_and_or_b32 v9, v9, s45, v48
  buffer_load_dwordx4 v[84:87], v9, s[16:19], 0 offen
  s_add_u32 s51, s48, s50
  s_mov_b32 m0, s51
  s_add_u32 s50, s50, 1024
  s_and_b32 s50, s50, 4095
  v_add_u32 v101, v101, v125
  buffer_load_dwordx4 v101, s[20:23], 0 offen lds
  v_and_b32 v10, 31, v10
  v_mad_u32_u24 v96, v10, 48, v51
  v_mad_u32_u24 v97, v10, v49, v122
  v_mad_u32_u24 v97, v123, s52, v97
  s_add_u32 s52, s52, 1
  s_and_b32 s52, s52, 7
  ds_read_b32 v100, v53 offset:0
  ds_read_b128 v[102:105], v54 offset:0
  v_add_u32 v53, 128, v53
  v_add_u32 v54, 128, v54
  s_mov_b64 exec, 0xffff
  ds_write_b16 v96, v55
  s_mov_b64 exec, -1
  ds_read_b64 v[126:127], v52
  s_mov_b64 exec, 0xffff
  ds_write_b16 v96, v12
  s_mov_b64 exec, -1
  ds_read_b128 v[92:95], v97
  s_waitcnt vmcnt(5)
  v_lshlrev_b32 v106, 16, v56
  v_lshlrev_b32 v107, 16, v60
  v_lshlrev_b32 v108, 16, v64
  v_lshlrev_b32 v109, 16, v68
  v_and_b32 v110, v15, v56
  v_and_b32 v111, v15, v60
  v_and_b32 v112, v15, v64
  v_and_b32 v113, v15, v68
  v_mfma_f32_16x16x32_bf16 v[106:109], v[88:91], v[16:19], v[106:109]
  v_lshlrev_b32 v114, 16, v57
  v_lshlrev_b32 v115, 16, v61
  v_lshlrev_b32 v116, 16, v65
  v_lshlrev_b32 v117, 16, v69
  v_mfma_f32_16x16x32_bf16 v[110:113], v[88:91], v[20:23], v[110:113]
  v_and_b32 v118, v15, v57
  v_and_b32 v119, v15, v61
  v_and_b32 v120, v15, v65
  v_and_b32 v121, v15, v69
  v_mfma_f32_16x16x32_bf16 v[114:117], v[88:91], v[24:27], v[114:117]
  v_lshlrev_b32 v56, 16, v58
  v_lshlrev_b32 v60, 16, v62
  v_mfma_f32_16x16x32_bf16 v[118:121], v[88:91], v[28:31], v[118:121]
  v_lshlrev_b32 v64, 16, v66
  v_lshlrev_b32 v68, 16, v70
  v_lshlrev_b32 v57, 16, v59
  v_lshlrev_b32 v61, 16, v63
  v_lshlrev_b32 v65, 16, v67
  v_lshlrev_b32 v69, 16, v71
  v_exp_f32 v106, v106
  v_exp_f32 v107, v107
  v_exp_f32 v108, v108
  v_exp_f32 v109, v109
  v_exp_f32 v110, v110
  v_exp_f32 v111, v111
  v_exp_f32 v112, v112
  v_exp_f32 v113, v113
  v_exp_f32 v114, v114
  v_exp_f32 v115, v115
  v_exp_f32 v116, v116
  v_exp_f32 v117, v117
  v_exp_f32 v118, v118
  v_exp_f32 v119, v119
  v_exp_f32 v120, v120
  v_exp_f32 v121, v121
  v_add_f32 v106, 1.0, v106
  v_add_f32 v107, 1.0, v107
  v_add_f32 v108, 1.0, v108
  v_add_f32 v109, 1.0, v109
  v_add_f32 v110, 1.0, v110
  v_add_f32 v111, 1.0, v111
  v_add_f32 v112, 1.0, v112
  v_add_f32 v113, 1.0, v113
  v_add_f32 v114, 1.0, v114
  v_add_f32 v115, 1.0, v115
  v_add_f32 v116, 1.0, v116
  v_add_f32 v117, 1.0, v117
  v_add_f32 v118, 1.0, v118
  v_add_f32 v119, 1.0, v119
  v_add_f32 v120, 1.0, v120
  v_add_f32 v121, 1.0, v121
  v_rcp_f32 v106, v106
  v_rcp_f32 v107, v107
  v_rcp_f32 v108, v108
  v_rcp_f32 v109, v109
  v_rcp_f32 v110, v110
  v_rcp_f32 v111, v111
  v_rcp_f32 v112, v112
  v_rcp_f32 v113, v113
  v_rcp_f32 v114, v114
  v_rcp_f32 v115, v115
  v_rcp_f32 v116, v116
  v_rcp_f32 v117, v117
  v_rcp_f32 v118, v118
  v_rcp_f32 v119, v119
  v_rcp_f32 v120, v120
  v_rcp_f32 v121, v121
  v_mul_f32 v106, v106, v56
  v_mul_f32 v107, v107, v60
  v_mul_f32 v108, v108, v64
  v_mul_f32 v109, v109, v68
  v_cvt_pk_bf16_f32 v106, v106, v107
  v_cvt_pk_bf16_f32 v107, v108, v109
  v_mul_f32 v110, v110, v58
  v_mul_f32 v111, v111, v62
  v_mul_f32 v112, v112, v66
  v_mul_f32 v113, v113, v70
  v_cvt_pk_bf16_f32 v110, v110, v111
  v_cvt_pk_bf16_f32 v111, v112, v113
  v_mul_f32 v114, v114, v57
  v_mul_f32 v115, v115, v61
  v_mul_f32 v116, v116, v65
  v_mul_f32 v117, v117, v69
  v_cvt_pk_bf16_f32 v114, v114, v115
  v_cvt_pk_bf16_f32 v115, v116, v117
  v_mul_f32 v118, v118, v59
  v_mul_f32 v119, v119, v63
  v_mul_f32 v120, v120, v67
  v_mul_f32 v121, v121, v71
  v_cvt_pk_bf16_f32 v118, v118, v119
  v_cvt_pk_bf16_f32 v119, v120, v121
  s_nop 0
  v_mfma_f32_16x16x16_bf16 v[32:35], v[98:99], v[106:107], v[32:35]
  v_mfma_f32_16x16x16_bf16 v[36:39], v[98:99], v[110:111], v[36:39]
  v_mfma_f32_16x16x16_bf16 v[40:43], v[98:99], v[114:115], v[40:43]
  v_mfma_f32_16x16x16_bf16 v[44:47], v[98:99], v[118:119], v[44:47]
  s_add_u32 s39, s39, 2
  s_cmp_ge_u32 s39, s38
  s_cbranch_scc1 K1_RDONE
  s_waitcnt lgkmcnt(0)
  v_and_or_b32 v102, v102, s45, v48
  buffer_load_dwordx4 v[56:59], v102, s[16:19], 0 offen
  v_and_or_b32 v103, v103, s45, v48
  buffer_load_dwordx4 v[60:63], v103, s[16:19], 0 offen
  v_and_or_b32 v104, v104, s45, v48
  buffer_load_dwordx4 v[64:67], v104, s[16:19], 0 offen
  v_and_or_b32 v105, v105, s45, v48
  buffer_load_dwordx4 v[68:71], v105, s[16:19], 0 offen
  v_and_b32 v100, 31, v100
  v_mad_u32_u24 v96, v100, 48, v51
  v_mad_u32_u24 v97, v100, v49, v122
  v_mad_u32_u24 v97, v123, s52, v97
  s_add_u32 s52, s52, 1
  s_and_b32 s52, s52, 7
  ds_read_b32 v10, v53 offset:0
  ds_read_b128 v[6:9], v54 offset:0
  v_add_u32 v53, 128, v53
  v_add_u32 v54, 128, v54
  ds_read_b32 v101, v124 offset:8864
  v_add_u32 v124, 256, v124
  s_mov_b64 exec, 0xffff
  ds_write_b16 v96, v55
  s_mov_b64 exec, -1
  ds_read_b64 v[98:99], v52
  s_mov_b64 exec, 0xffff
  ds_write_b16 v96, v12
  s_mov_b64 exec, -1
  ds_read_b128 v[88:91], v97
  s_waitcnt vmcnt(5)
  v_lshlrev_b32 v106, 16, v72
  v_lshlrev_b32 v107, 16, v76
  v_lshlrev_b32 v108, 16, v80
  v_lshlrev_b32 v109, 16, v84
  v_and_b32 v110, v15, v72
  v_and_b32 v111, v15, v76
  v_and_b32 v112, v15, v80
  v_and_b32 v113, v15, v84
  v_mfma_f32_16x16x32_bf16 v[106:109], v[92:95], v[16:19], v[106:109]
  v_lshlrev_b32 v114, 16, v73
  v_lshlrev_b32 v115, 16, v77
  v_lshlrev_b32 v116, 16, v81
  v_lshlrev_b32 v117, 16, v85
  v_mfma_f32_16x16x32_bf16 v[110:113], v[92:95], v[20:23], v[110:113]
  v_and_b32 v118, v15, v73
  v_and_b32 v119, v15, v77
  v_and_b32 v120, v15, v81
  v_and_b32 v121, v15, v85
  v_mfma_f32_16x16x32_bf16 v[114:117], v[92:95], v[24:27], v[114:117]
  v_lshlrev_b32 v72, 16, v74
  v_lshlrev_b32 v76, 16, v78
  v_mfma_f32_16x16x32_bf16 v[118:121], v[92:95], v[28:31], v[118:121]
  v_lshlrev_b32 v80, 16, v82
  v_lshlrev_b32 v84, 16, v86
  v_lshlrev_b32 v73, 16, v75
  v_lshlrev_b32 v77, 16, v79
  v_lshlrev_b32 v81, 16, v83
  v_lshlrev_b32 v85, 16, v87
  v_exp_f32 v106, v106
  v_exp_f32 v107, v107
  v_exp_f32 v108, v108
  v_exp_f32 v109, v109
  v_exp_f32 v110, v110
  v_exp_f32 v111, v111
  v_exp_f32 v112, v112
  v_exp_f32 v113, v113
  v_exp_f32 v114, v114
  v_exp_f32 v115, v115
  v_exp_f32 v116, v116
  v_exp_f32 v117, v117
  v_exp_f32 v118, v118
  v_exp_f32 v119, v119
  v_exp_f32 v120, v120
  v_exp_f32 v121, v121
  v_add_f32 v106, 1.0, v106
  v_add_f32 v107, 1.0, v107
  v_add_f32 v108, 1.0, v108
  v_add_f32 v109, 1.0, v109
  v_add_f32 v110, 1.0, v110
  v_add_f32 v111, 1.0, v111
  v_add_f32 v112, 1.0, v112
  v_add_f32 v113, 1.0, v113
  v_add_f32 v114, 1.0, v114
  v_add_f32 v115, 1.0, v115
  v_add_f32 v116, 1.0, v116
  v_add_f32 v117, 1.0, v117
  v_add_f32 v118, 1.0, v118
  v_add_f32 v119, 1.0, v119
  v_add_f32 v120, 1.0, v120
  v_add_f32 v121, 1.0, v121
  v_rcp_f32 v106, v106
  v_rcp_f32 v107, v107
  v_rcp_f32 v108, v108
  v_rcp_f32 v109, v109
  v_rcp_f32 v110, v110
  v_rcp_f32 v111, v111
  v_rcp_f32 v112, v112
  v_rcp_f32 v113, v113
  v_rcp_f32 v114, v114
  v_rcp_f32 v115, v115
  v_rcp_f32 v116, v116
  v_rcp_f32 v117, v117
  v_rcp_f32 v118, v118
  v_rcp_f32 v119, v119
  v_rcp_f32 v120, v120
  v_rcp_f32 v121, v121
  v_mul_f32 v106, v106, v72
  v_mul_f32 v107, v107, v76
  v_mul_f32 v108, v108, v80
  v_mul_f32 v109, v109, v84
  v_cvt_pk_bf16_f32 v106, v106, v107
  v_cvt_pk_bf16_f32 v107, v108, v109
  v_mul_f32 v110, v110, v74
  v_mul_f32 v111, v111, v78
  v_mul_f32 v112, v112, v82
  v_mul_f32 v113, v113, v86
  v_cvt_pk_bf16_f32 v110, v110, v111
  v_cvt_pk_bf16_f32 v111, v112, v113
  v_mul_f32 v114, v114, v73
  v_mul_f32 v115, v115, v77
  v_mul_f32 v116, v116, v81
  v_mul_f32 v117, v117, v85
  v_cvt_pk_bf16_f32 v114, v114, v115
  v_cvt_pk_bf16_f32 v115, v116, v117
  v_mul_f32 v118, v118, v75
  v_mul_f32 v119, v119, v79
  v_mul_f32 v120, v120, v83
  v_mul_f32 v121, v121, v87
  v_cvt_pk_bf16_f32 v118, v118, v119
  v_cvt_pk_bf16_f32 v119, v120, v121
  s_nop 0
  v_mfma_f32_16x16x16_bf16 v[32:35], v[126:127], v[106:107], v[32:35]
  v_mfma_f32_16x16x16_bf16 v[36:39], v[126:127], v[110:111], v[36:39]
  v_mfma_f32_16x16x16_bf16 v[40:43], v[126:127], v[114:115], v[40:43]
  v_mfma_f32_16x16x16_bf16 v[44:47], v[126:127], v[118:119], v[44:47]
  s_add_u32 s39, s39, 2
  s_cmp_lt_u32 s39, s38
  s_cbranch_scc1 K1_LOOP
K1_RDONE:
  s_setprio 3
  s_waitcnt vmcnt(0) lgkmcnt(0)
  s_barrier
  s_waitcnt vmcnt(0)
  s_cmp_lt_i32 s36, 0
  s_cbranch_scc1 K1_ROUND
  s_nop 7
  v_mul_u32_u24 v6, 2112, v2
  v_lshl_add_u32 v6, v1, 2, v6
  s_mul_i32 s33, s14, 8448
  s_lshl_b32 s34, s13, 8
  s_add_u32 s33, s33, s34
  v_add_u32 v6, s33, v6
  ds_write_b32 v6, v32 offset:0
  ds_write_b32 v6, v33 offset:528
  ds_write_b32 v6, v34 offset:1056
  ds_write_b32 v6, v35 offset:1584
  ds_write_b32 v6, v36 offset:64
  ds_write_b32 v6, v37 offset:592
  ds_write_b32 v6, v38 offset:1120
  ds_write_b32 v6, v39 offset:1648
  ds_write_b32 v6, v40 offset:128
  ds_write_b32 v6, v41 offset:656
  ds_write_b32 v6, v42 offset:1184
  ds_write_b32 v6, v43 offset:1712
  ds_write_b32 v6, v44 offset:192
  ds_write_b32 v6, v45 offset:720
  ds_write_b32 v6, v46 offset:1248
  ds_write_b32 v6, v47 offset:1776
  s_waitcnt lgkmcnt(0)
  s_barrier
  v_lshrrev_b32 v6, 4, v0
  v_mul_u32_u24 v7, 528, v6
  v_lshl_add_u32 v7, v1, 5, v7
  ds_read_b128 v[64:67], v7
  ds_read_b128 v[68:71], v7 offset:16
  ds_read_b128 v[72:75], v7 offset:8448
  ds_read_b128 v[76:79], v7 offset:8464
  s_mov_b32 s33, 3216550459
  s_waitcnt lgkmcnt(0)
  v_add_f32 v64, v64, v72
  v_add_f32 v65, v65, v73
  v_add_f32 v66, v66, v74
  v_add_f32 v67, v67, v75
  v_add_f32 v68, v68, v76
  v_add_f32 v69, v69, v77
  v_add_f32 v70, v70, v78
  v_add_f32 v71, v71, v79
  v_mul_f32 v72, s33, v64
  v_mul_f32 v73, s33, v65
  v_mul_f32 v74, s33, v66
  v_mul_f32 v75, s33, v67
  v_mul_f32 v76, s33, v68
  v_mul_f32 v77, s33, v69
  v_mul_f32 v78, s33, v70
  v_mul_f32 v79, s33, v71
  v_exp_f32 v72, v72
  v_exp_f32 v73, v73
  v_exp_f32 v74, v74
  v_exp_f32 v75, v75
  v_exp_f32 v76, v76
  v_exp_f32 v77, v77
  v_exp_f32 v78, v78
  v_exp_f32 v79, v79
  s_nop 0
  v_add_f32 v72, 1.0, v72
  v_add_f32 v73, 1.0, v73
  v_add_f32 v74, 1.0, v74
  v_add_f32 v75, 1.0, v75
  v_add_f32 v76, 1.0, v76
  v_add_f32 v77, 1.0, v77
  v_add_f32 v78, 1.0, v78
  v_add_f32 v79, 1.0, v79
  v_rcp_f32 v72, v72
  v_rcp_f32 v73, v73
  v_rcp_f32 v74, v74
  v_rcp_f32 v75, v75
  v_rcp_f32 v76, v76
  v_rcp_f32 v77, v77
  v_rcp_f32 v78, v78
  v_rcp_f32 v79, v79
  s_nop 0
  v_mul_f32 v64, v64, v72
  v_mul_f32 v65, v65, v73
  v_mul_f32 v66, v66, v74
  v_mul_f32 v67, v67, v75
  v_mul_f32 v68, v68, v76
  v_mul_f32 v69, v69, v77
  v_mul_f32 v70, v70, v78
  v_mul_f32 v71, v71, v79
  v_cvt_pk_bf16_f32 v80, v64, v65
  v_cvt_pk_bf16_f32 v81, v66, v67
  v_cvt_pk_bf16_f32 v82, v68, v69
  v_cvt_pk_bf16_f32 v83, v70, v71
  v_lshlrev_b32 v7, 8, v6
  v_lshl_add_u32 v7, v1, 4, v7
  s_lshl_b32 s33, s10, 8
  v_cmp_gt_u32 vcc, s11, v6
  s_and_saveexec_b64 s[30:31], vcc
  s_cbranch_execz K1_DONE
  buffer_store_dwordx4 v[80:83], v7, s[24:27], s33 offen
K1_DONE:
  s_endpgm
.section .rodata,"a"
.p2align 6
.amdhsa_kernel mpnn_prep_kernel
  .amdhsa_next_free_vgpr 192
  .amdhsa_next_free_sgpr 96
  .amdhsa_accum_offset 192
  .amdhsa_group_segment_fixed_size 0
  .amdhsa_kernarg_size 80
  .amdhsa_user_sgpr_count 2
  .amdhsa_user_sgpr_kernarg_segment_ptr 1
  .amdhsa_system_sgpr_workgroup_id_x 1
.end_amdhsa_kernel
.p2align 6
.amdhsa_kernel mpnn_main_kernel
  .amdhsa_next_free_vgpr 128
  .amdhsa_next_free_sgpr 96
  .amdhsa_accum_offset 128
  .amdhsa_group_segment_fixed_size 0
  .amdhsa_kernarg_size 80
  .amdhsa_user_sgpr_count 2
  .amdhsa_user_sgpr_kernarg_segment_ptr 1
  .amdhsa_system_sgpr_workgroup_id_x 1
.end_amdhsa_kernel
```
